```python
import torch

def _softmax(x, axis=-1):
    return torch.softmax(x, dim=axis)
def _gelu(x):
    return torch.nn.functional.gelu(x, approximate="tanh")
def _silu(x):
    return torch.nn.functional.silu(x)
def _sigmoid(x):
    return torch.sigmoid(x)
def _layernorm(x, axis=-1, eps=1e-5):
    m = x.mean(dim=axis, keepdim=True)
    v = x.var(dim=axis, keepdim=True, unbiased=False)
    return (x - m) / torch.sqrt(v + eps)
def _scatter_add(tgt, idx, src, axis=0):
    return tgt.clone().index_add_(axis, idx, src)
def _segment_sum(src, seg, n):
    out = torch.zeros((n,) + src.shape[1:], dtype=src.dtype)
    return out.index_add_(0, seg, src)
def _pad(x, pw):
    flat = tuple(v for pair in reversed(pw) for v in pair)
    return torch.nn.functional.pad(x, flat)

kernel_name = 'standalone__gqa_block_cached__sampling'

def setup_inputs():

    _w = (lambda a: (lambda t: t.to(torch.bfloat16) if t.is_floating_point() else t)(torch.as_tensor(a)))
    B, Sq, D = 32, 4, 576
    Hq, Hkv, Sk, Dh = 32, 16, 2048, 128
    assert Hq % Hkv == 0, (Hq, Hkv)
    return {
        "x": _w((lambda *s: torch.randn(*s, dtype=torch.bfloat16) * 0.8)(B, Sq, D)),
        "k_cache": _w((lambda *s: torch.randn(*s, dtype=torch.bfloat16) * 0.8)(B, Hkv, Sk, Dh)),
        "v_cache": _w((lambda *s: torch.randn(*s, dtype=torch.bfloat16) * 0.05)(B, Hkv, Sk, Dh)),
        "wq": _w((lambda *s: torch.randn(*s, dtype=torch.bfloat16) * 0.8)(D, Hq * Dh) * (D ** -0.5)),
        "wo": _w((lambda *s: torch.randn(*s, dtype=torch.bfloat16) * 0.05)(Hq * Dh, D) * ((Hq * Dh) ** -0.5)),
    }

def reference(x, k_cache, v_cache, wq, wo):
    B, Sq, D = x.shape
    Hq, Dh = 32, 128
    Hkv = k_cache.shape[1]
    rep = Hq // Hkv
    q = (lambda x, *d: x.permute(*d))((x @ wq).reshape(B, Sq, Hq, Dh), 0, 2, 1, 3)
    k = (lambda x, n, axis: torch.repeat_interleave(x, n, dim=axis))(k_cache, rep, axis=1)
    v = (lambda x, n, axis: torch.repeat_interleave(x, n, dim=axis))(v_cache, rep, axis=1)
    scores = torch.einsum("bhqd,bhkd->bhqk", q, k) * (Dh ** -0.5)
    p = _softmax(scores, axis=-1)
    o = torch.einsum("bhqk,bhkd->bhqd", p, v)
    return (lambda x, *d: x.permute(*d))(o, 0, 2, 1, 3).reshape(B, Sq, Hq * Dh) @ wo
```

```asm
; @launch grid=(256,1,1) block=(512,1,1) lds=157216
.amdgcn_target "amdgcn-amd-amdhsa--gfx950"
.text
.globl standalone__gqa_block_cached__sampling_kernel
.p2align 8
.type standalone__gqa_block_cached__sampling_kernel,@function
standalone__gqa_block_cached__sampling_kernel:
  s_cmp_lt_u32 s2, 256
  s_cbranch_scc1 L_main
L_end0:
  s_endpgm
L_main:
  s_load_dwordx8 s[32:39], s[0:1], 0
  s_load_dwordx8 s[40:47], s[0:1], 32
  v_lshrrev_b32 v1, 6, v0
  v_and_b32 v0, 63, v0
  v_readfirstlane_b32 s3, v1
  v_and_b32 v14, 15, v0
  v_lshrrev_b32 v15, 4, v0
  s_lshr_b32 s55, s2, 1
  s_xor_b32 s55, s55, s2
  s_and_b32 s55, s55, 4
  s_mul_i32 s55, s55, 3
  s_xor_b32 s48, s55, s2
  s_and_b32 s48, s48, 15
  s_lshr_b32 s49, s2, 4
  s_cmp_lt_u32 s3, 4
  s_cbranch_scc1 L_kv
  s_setprio 3
  v_lshlrev_b32 v11, 16, v15
  v_lshl_add_u32 v1, v14, 4, v11
  v_and_b32 v12, 7, v14
  v_mul_u32_u24 v11, 1152, v12
  v_lshl_add_u32 v11, v15, 4, v11
  s_mul_i32 s62, s49, 9
  s_lshr_b32 s62, s62, 4
  v_lshrrev_b32 v13, 3, v14
  v_add_u32 v10, s62, v13
  v_lshlrev_b32 v10, 6, v10
  s_mov_b32 s19, 0x00020000
  s_mov_b32 s23, 0x00020000
  s_and_b32 s56, s3, 1
  s_bfe_u32 s58, s3, 0x10001
  s_mul_i32 s57, s56, 2359296
  s_lshl_b32 s55, s48, 9
  s_add_u32 s57, s57, s55
  s_lshl_b32 s55, s58, 8
  s_add_u32 s57, s57, s55
  s_sub_u32 s18, 4718592, s57
  s_mul_i32 s53, s56, 576
  s_mul_i32 s55, s49, 9216
  s_add_u32 s53, s53, s55
  s_sub_u32 s22, 147456, s53
  v_add_u32 v8, 0, v10
  v_add_u32 v9, -576, v10
  v_min_u32 v8, v8, v9
  v_add_u32 v2, v8, v11
  v_add_u32 v8, 128, v10
  v_add_u32 v9, -448, v10
  v_min_u32 v8, v8, v9
  v_add_u32 v3, v8, v11
  v_add_u32 v8, 256, v10
  v_add_u32 v9, -320, v10
  v_min_u32 v8, v8, v9
  v_add_u32 v4, v8, v11
  v_add_u32 v8, 384, v10
  v_add_u32 v9, -192, v10
  v_min_u32 v8, v8, v9
  v_add_u32 v5, v8, v11
  v_add_u32 v8, 512, v10
  v_add_u32 v9, -64, v10
  v_min_u32 v8, v8, v9
  v_add_u32 v6, v8, v11
  s_waitcnt lgkmcnt(0)
  s_add_u32 s16, s38, s57
  s_addc_u32 s17, s39, 0
  s_add_u32 s20, s32, s53
  s_addc_u32 s21, s33, 0
  buffer_load_dwordx4 v[16:19], v2, s[20:23], 0 offen
  buffer_load_dwordx4 v[20:23], v3, s[20:23], 0 offen
  buffer_load_dwordx4 v[24:27], v4, s[20:23], 0 offen
  buffer_load_dwordx4 v[28:31], v5, s[20:23], 0 offen
  buffer_load_dwordx4 v[32:35], v6, s[20:23], 0 offen
  s_lshl_b32 s54, s62, 18
  buffer_load_dwordx4 v[76:79], v1, s[16:19], s54 offen
  s_add_u32 s54, s54, 8192
  buffer_load_dwordx4 v[80:83], v1, s[16:19], s54 offen
  s_add_u32 s54, s54, 8192
  buffer_load_dwordx4 v[84:87], v1, s[16:19], s54 offen
  s_add_u32 s54, s54, 8192
  buffer_load_dwordx4 v[88:91], v1, s[16:19], s54 offen
  s_add_u32 s54, s54, 8192
  buffer_load_dwordx4 v[92:95], v1, s[16:19], s54 offen
  s_add_u32 s54, s54, 8192
  buffer_load_dwordx4 v[96:99], v1, s[16:19], s54 offen
  s_add_u32 s54, s54, 8192
  buffer_load_dwordx4 v[100:103], v1, s[16:19], s54 offen
  s_add_u32 s54, s54, 8192
  buffer_load_dwordx4 v[104:107], v1, s[16:19], s54 offen
  s_add_u32 s62, s62, 1
  s_cmp_eq_u32 s62, 9
  s_cselect_b32 s62, 0, s62
  s_barrier
  s_lshl_b32 s54, s62, 18
  buffer_load_dwordx4 v[108:111], v1, s[16:19], s54 offen
  s_add_u32 s54, s54, 8192
  buffer_load_dwordx4 v[112:115], v1, s[16:19], s54 offen
  s_add_u32 s54, s54, 8192
  buffer_load_dwordx4 v[116:119], v1, s[16:19], s54 offen
  s_add_u32 s54, s54, 8192
  buffer_load_dwordx4 v[120:123], v1, s[16:19], s54 offen
  s_add_u32 s54, s54, 8192
  buffer_load_dwordx4 v[124:127], v1, s[16:19], s54 offen
  s_add_u32 s54, s54, 8192
  buffer_load_dwordx4 v[128:131], v1, s[16:19], s54 offen
  s_add_u32 s54, s54, 8192
  buffer_load_dwordx4 v[132:135], v1, s[16:19], s54 offen
  s_add_u32 s54, s54, 8192
  buffer_load_dwordx4 v[136:139], v1, s[16:19], s54 offen
  s_add_u32 s62, s62, 1
  s_cmp_eq_u32 s62, 9
  s_cselect_b32 s62, 0, s62
  s_lshl_b32 s54, s62, 18
  buffer_load_dwordx4 v[140:143], v1, s[16:19], s54 offen
  s_add_u32 s54, s54, 8192
  buffer_load_dwordx4 v[144:147], v1, s[16:19], s54 offen
  s_add_u32 s54, s54, 8192
  buffer_load_dwordx4 v[148:151], v1, s[16:19], s54 offen
  s_add_u32 s54, s54, 8192
  buffer_load_dwordx4 v[152:155], v1, s[16:19], s54 offen
  s_add_u32 s54, s54, 8192
  buffer_load_dwordx4 v[156:159], v1, s[16:19], s54 offen
  s_add_u32 s54, s54, 8192
  buffer_load_dwordx4 v[160:163], v1, s[16:19], s54 offen
  s_add_u32 s54, s54, 8192
  buffer_load_dwordx4 v[164:167], v1, s[16:19], s54 offen
  s_add_u32 s54, s54, 8192
  buffer_load_dwordx4 v[168:171], v1, s[16:19], s54 offen
  s_add_u32 s62, s62, 1
  s_cmp_eq_u32 s62, 9
  s_cselect_b32 s62, 0, s62
  s_mov_b32 s50, 0x05040100
  s_mov_b32 s51, 0x07060302
  s_mov_b32 s60, 0xff00ff00
  s_mov_b32 s61, 0xff00ff00
  v_mul_u32_u24 v11, 1040, v12
  v_lshl_add_u32 v13, v15, 1, v13
  v_lshl_add_u32 v11, v13, 6, v11
  s_mul_i32 s55, s56, 8320
  s_lshl_b32 s58, s58, 9
  s_add_u32 s55, s55, s58
  s_add_u32 s55, s55, 140320
  v_add_u32 v7, s55, v11
  v_mov_b32 v8, 131072
  v_mov_b32 v9, 1
  s_waitcnt vmcnt(16)
  s_lshl_b32 s54, s62, 18
  buffer_load_dwordx4 v[172:175], v1, s[16:19], s54 offen
  s_add_u32 s54, s54, 8192
  buffer_load_dwordx4 v[176:179], v1, s[16:19], s54 offen
  s_add_u32 s54, s54, 8192
  buffer_load_dwordx4 v[180:183], v1, s[16:19], s54 offen
  s_add_u32 s54, s54, 8192
  buffer_load_dwordx4 v[184:187], v1, s[16:19], s54 offen
  s_add_u32 s54, s54, 8192
  buffer_load_dwordx4 v[188:191], v1, s[16:19], s54 offen
  s_add_u32 s54, s54, 8192
  buffer_load_dwordx4 v[192:195], v1, s[16:19], s54 offen
  s_add_u32 s54, s54, 8192
  buffer_load_dwordx4 v[196:199], v1, s[16:19], s54 offen
  s_add_u32 s54, s54, 8192
  buffer_load_dwordx4 v[200:203], v1, s[16:19], s54 offen
  s_add_u32 s62, s62, 1
  s_cmp_eq_u32 s62, 9
  s_cselect_b32 s62, 0, s62
  v_mov_b32_dpp v36, v16 quad_perm:[0,1,2,3] row_mask:0xf bank_mask:0x3
  v_mov_b32_dpp v36, v16 row_ror:8 row_mask:0xf bank_mask:0xc
  v_mov_b32_dpp v37, v17 quad_perm:[0,1,2,3] row_mask:0xf bank_mask:0x3
  v_mov_b32_dpp v37, v17 row_ror:8 row_mask:0xf bank_mask:0xc
  v_mov_b32_dpp v38, v18 quad_perm:[0,1,2,3] row_mask:0xf bank_mask:0x3
  v_mov_b32_dpp v38, v18 row_ror:8 row_mask:0xf bank_mask:0xc
  v_mov_b32_dpp v39, v19 quad_perm:[0,1,2,3] row_mask:0xf bank_mask:0x3
  v_mov_b32_dpp v39, v19 row_ror:8 row_mask:0xf bank_mask:0xc
  v_perm_b32 v204, v80, v76, s50
  v_perm_b32 v205, v88, v84, s50
  v_perm_b32 v206, v96, v92, s50
  v_perm_b32 v207, v104, v100, s50
  v_perm_b32 v208, v80, v76, s51
  v_perm_b32 v209, v88, v84, s51
  v_perm_b32 v210, v96, v92, s51
  v_perm_b32 v211, v104, v100, s51
  v_mfma_f32_16x16x32_bf16 v[44:47], v[204:207], v[36:39], 0
  v_perm_b32 v204, v81, v77, s50
  v_perm_b32 v205, v89, v85, s50
  v_perm_b32 v206, v97, v93, s50
  v_perm_b32 v207, v105, v101, s50
  v_mfma_f32_16x16x32_bf16 v[48:51], v[208:211], v[36:39], 0
  v_perm_b32 v208, v81, v77, s51
  v_perm_b32 v209, v89, v85, s51
  v_perm_b32 v210, v97, v93, s51
  v_perm_b32 v211, v105, v101, s51
  v_mfma_f32_16x16x32_bf16 v[52:55], v[204:207], v[36:39], 0
  v_perm_b32 v204, v82, v78, s50
  v_perm_b32 v205, v90, v86, s50
  v_perm_b32 v206, v98, v94, s50
  v_perm_b32 v207, v106, v102, s50
  v_mfma_f32_16x16x32_bf16 v[56:59], v[208:211], v[36:39], 0
  v_perm_b32 v208, v82, v78, s51
  v_perm_b32 v209, v90, v86, s51
  v_perm_b32 v210, v98, v94, s51
  v_perm_b32 v211, v106, v102, s51
  v_mfma_f32_16x16x32_bf16 v[60:63], v[204:207], v[36:39], 0
  v_perm_b32 v204, v83, v79, s50
  v_perm_b32 v205, v91, v87, s50
  v_perm_b32 v206, v99, v95, s50
  v_perm_b32 v207, v107, v103, s50
  v_mfma_f32_16x16x32_bf16 v[64:67], v[208:211], v[36:39], 0
  v_perm_b32 v208, v83, v79, s51
  v_perm_b32 v209, v91, v87, s51
  v_perm_b32 v210, v99, v95, s51
  v_perm_b32 v211, v107, v103, s51
  v_mfma_f32_16x16x32_bf16 v[68:71], v[204:207], v[36:39], 0
  s_nop 1
  v_mfma_f32_16x16x32_bf16 v[72:75], v[208:211], v[36:39], 0
  s_waitcnt vmcnt(16)
  s_lshl_b32 s54, s62, 18
  buffer_load_dwordx4 v[76:79], v1, s[16:19], s54 offen
  s_add_u32 s54, s54, 8192
  buffer_load_dwordx4 v[80:83], v1, s[16:19], s54 offen
  s_add_u32 s54, s54, 8192
  buffer_load_dwordx4 v[84:87], v1, s[16:19], s54 offen
  s_add_u32 s54, s54, 8192
  buffer_load_dwordx4 v[88:91], v1, s[16:19], s54 offen
  s_add_u32 s54, s54, 8192
  buffer_load_dwordx4 v[92:95], v1, s[16:19], s54 offen
  s_add_u32 s54, s54, 8192
  buffer_load_dwordx4 v[96:99], v1, s[16:19], s54 offen
  s_add_u32 s54, s54, 8192
  buffer_load_dwordx4 v[100:103], v1, s[16:19], s54 offen
  s_add_u32 s54, s54, 8192
  buffer_load_dwordx4 v[104:107], v1, s[16:19], s54 offen
  s_add_u32 s62, s62, 1
  s_cmp_eq_u32 s62, 9
  s_cselect_b32 s62, 0, s62
  v_mov_b32_dpp v40, v16 quad_perm:[0,1,2,3] row_mask:0xf bank_mask:0xc
  v_mov_b32_dpp v40, v16 row_ror:8 row_mask:0xf bank_mask:0x3
  v_mov_b32_dpp v41, v17 quad_perm:[0,1,2,3] row_mask:0xf bank_mask:0xc
  v_mov_b32_dpp v41, v17 row_ror:8 row_mask:0xf bank_mask:0x3
  v_mov_b32_dpp v42, v18 quad_perm:[0,1,2,3] row_mask:0xf bank_mask:0xc
  v_mov_b32_dpp v42, v18 row_ror:8 row_mask:0xf bank_mask:0x3
  v_mov_b32_dpp v43, v19 quad_perm:[0,1,2,3] row_mask:0xf bank_mask:0xc
  v_mov_b32_dpp v43, v19 row_ror:8 row_mask:0xf bank_mask:0x3
  v_perm_b32 v204, v112, v108, s50
  v_perm_b32 v205, v120, v116, s50
  v_perm_b32 v206, v128, v124, s50
  v_perm_b32 v207, v136, v132, s50
  v_perm_b32 v208, v112, v108, s51
  v_perm_b32 v209, v120, v116, s51
  v_perm_b32 v210, v128, v124, s51
  v_perm_b32 v211, v136, v132, s51
  v_mfma_f32_16x16x32_bf16 v[44:47], v[204:207], v[40:43], v[44:47]
  v_perm_b32 v204, v113, v109, s50
  v_perm_b32 v205, v121, v117, s50
  v_perm_b32 v206, v129, v125, s50
  v_perm_b32 v207, v137, v133, s50
  v_mfma_f32_16x16x32_bf16 v[48:51], v[208:211], v[40:43], v[48:51]
  v_perm_b32 v208, v113, v109, s51
  v_perm_b32 v209, v121, v117, s51
  v_perm_b32 v210, v129, v125, s51
  v_perm_b32 v211, v137, v133, s51
  v_mfma_f32_16x16x32_bf16 v[52:55], v[204:207], v[40:43], v[52:55]
  v_perm_b32 v204, v114, v110, s50
  v_perm_b32 v205, v122, v118, s50
  v_perm_b32 v206, v130, v126, s50
  v_perm_b32 v207, v138, v134, s50
  v_mfma_f32_16x16x32_bf16 v[56:59], v[208:211], v[40:43], v[56:59]
  v_perm_b32 v208, v114, v110, s51
  v_perm_b32 v209, v122, v118, s51
  v_perm_b32 v210, v130, v126, s51
  v_perm_b32 v211, v138, v134, s51
  v_mfma_f32_16x16x32_bf16 v[60:63], v[204:207], v[40:43], v[60:63]
  v_perm_b32 v204, v115, v111, s50
  v_perm_b32 v205, v123, v119, s50
  v_perm_b32 v206, v131, v127, s50
  v_perm_b32 v207, v139, v135, s50
  v_mfma_f32_16x16x32_bf16 v[64:67], v[208:211], v[40:43], v[64:67]
  v_perm_b32 v208, v115, v111, s51
  v_perm_b32 v209, v123, v119, s51
  v_perm_b32 v210, v131, v127, s51
  v_perm_b32 v211, v139, v135, s51
  v_mfma_f32_16x16x32_bf16 v[68:71], v[204:207], v[40:43], v[68:71]
  s_nop 1
  v_mfma_f32_16x16x32_bf16 v[72:75], v[208:211], v[40:43], v[72:75]
  s_waitcnt vmcnt(16)
  s_lshl_b32 s54, s62, 18
  buffer_load_dwordx4 v[108:111], v1, s[16:19], s54 offen
  s_add_u32 s54, s54, 8192
  buffer_load_dwordx4 v[112:115], v1, s[16:19], s54 offen
  s_add_u32 s54, s54, 8192
  buffer_load_dwordx4 v[116:119], v1, s[16:19], s54 offen
  s_add_u32 s54, s54, 8192
  buffer_load_dwordx4 v[120:123], v1, s[16:19], s54 offen
  s_add_u32 s54, s54, 8192
  buffer_load_dwordx4 v[124:127], v1, s[16:19], s54 offen
  s_add_u32 s54, s54, 8192
  buffer_load_dwordx4 v[128:131], v1, s[16:19], s54 offen
  s_add_u32 s54, s54, 8192
  buffer_load_dwordx4 v[132:135], v1, s[16:19], s54 offen
  s_add_u32 s54, s54, 8192
  buffer_load_dwordx4 v[136:139], v1, s[16:19], s54 offen
  s_add_u32 s62, s62, 1
  s_cmp_eq_u32 s62, 9
  s_cselect_b32 s62, 0, s62
  v_mov_b32_dpp v36, v20 quad_perm:[0,1,2,3] row_mask:0xf bank_mask:0x3
  v_mov_b32_dpp v36, v20 row_ror:8 row_mask:0xf bank_mask:0xc
  v_mov_b32_dpp v37, v21 quad_perm:[0,1,2,3] row_mask:0xf bank_mask:0x3
  v_mov_b32_dpp v37, v21 row_ror:8 row_mask:0xf bank_mask:0xc
  v_mov_b32_dpp v38, v22 quad_perm:[0,1,2,3] row_mask:0xf bank_mask:0x3
  v_mov_b32_dpp v38, v22 row_ror:8 row_mask:0xf bank_mask:0xc
  v_mov_b32_dpp v39, v23 quad_perm:[0,1,2,3] row_mask:0xf bank_mask:0x3
  v_mov_b32_dpp v39, v23 row_ror:8 row_mask:0xf bank_mask:0xc
  v_perm_b32 v204, v144, v140, s50
  v_perm_b32 v205, v152, v148, s50
  v_perm_b32 v206, v160, v156, s50
  v_perm_b32 v207, v168, v164, s50
  v_perm_b32 v208, v144, v140, s51
  v_perm_b32 v209, v152, v148, s51
  v_perm_b32 v210, v160, v156, s51
  v_perm_b32 v211, v168, v164, s51
  v_mfma_f32_16x16x32_bf16 v[44:47], v[204:207], v[36:39], v[44:47]
  v_perm_b32 v204, v145, v141, s50
  v_perm_b32 v205, v153, v149, s50
  v_perm_b32 v206, v161, v157, s50
  v_perm_b32 v207, v169, v165, s50
  v_mfma_f32_16x16x32_bf16 v[48:51], v[208:211], v[36:39], v[48:51]
  v_perm_b32 v208, v145, v141, s51
  v_perm_b32 v209, v153, v149, s51
  v_perm_b32 v210, v161, v157, s51
  v_perm_b32 v211, v169, v165, s51
  v_mfma_f32_16x16x32_bf16 v[52:55], v[204:207], v[36:39], v[52:55]
  v_perm_b32 v204, v146, v142, s50
  v_perm_b32 v205, v154, v150, s50
  v_perm_b32 v206, v162, v158, s50
  v_perm_b32 v207, v170, v166, s50
  v_mfma_f32_16x16x32_bf16 v[56:59], v[208:211], v[36:39], v[56:59]
  v_perm_b32 v208, v146, v142, s51
  v_perm_b32 v209, v154, v150, s51
  v_perm_b32 v210, v162, v158, s51
  v_perm_b32 v211, v170, v166, s51
  v_mfma_f32_16x16x32_bf16 v[60:63], v[204:207], v[36:39], v[60:63]
  v_perm_b32 v204, v147, v143, s50
  v_perm_b32 v205, v155, v151, s50
  v_perm_b32 v206, v163, v159, s50
  v_perm_b32 v207, v171, v167, s50
  v_mfma_f32_16x16x32_bf16 v[64:67], v[208:211], v[36:39], v[64:67]
  v_perm_b32 v208, v147, v143, s51
  v_perm_b32 v209, v155, v151, s51
  v_perm_b32 v210, v163, v159, s51
  v_perm_b32 v211, v171, v167, s51
  v_mfma_f32_16x16x32_bf16 v[68:71], v[204:207], v[36:39], v[68:71]
  s_nop 1
  v_mfma_f32_16x16x32_bf16 v[72:75], v[208:211], v[36:39], v[72:75]
  s_waitcnt vmcnt(16)
  s_lshl_b32 s54, s62, 18
  buffer_load_dwordx4 v[140:143], v1, s[16:19], s54 offen
  s_add_u32 s54, s54, 8192
  buffer_load_dwordx4 v[144:147], v1, s[16:19], s54 offen
  s_add_u32 s54, s54, 8192
  buffer_load_dwordx4 v[148:151], v1, s[16:19], s54 offen
  s_add_u32 s54, s54, 8192
  buffer_load_dwordx4 v[152:155], v1, s[16:19], s54 offen
  s_add_u32 s54, s54, 8192
  buffer_load_dwordx4 v[156:159], v1, s[16:19], s54 offen
  s_add_u32 s54, s54, 8192
  buffer_load_dwordx4 v[160:163], v1, s[16:19], s54 offen
  s_add_u32 s54, s54, 8192
  buffer_load_dwordx4 v[164:167], v1, s[16:19], s54 offen
  s_add_u32 s54, s54, 8192
  buffer_load_dwordx4 v[168:171], v1, s[16:19], s54 offen
  s_add_u32 s62, s62, 1
  s_cmp_eq_u32 s62, 9
  s_cselect_b32 s62, 0, s62
  v_mov_b32_dpp v40, v20 quad_perm:[0,1,2,3] row_mask:0xf bank_mask:0xc
  v_mov_b32_dpp v40, v20 row_ror:8 row_mask:0xf bank_mask:0x3
  v_mov_b32_dpp v41, v21 quad_perm:[0,1,2,3] row_mask:0xf bank_mask:0xc
  v_mov_b32_dpp v41, v21 row_ror:8 row_mask:0xf bank_mask:0x3
  v_mov_b32_dpp v42, v22 quad_perm:[0,1,2,3] row_mask:0xf bank_mask:0xc
  v_mov_b32_dpp v42, v22 row_ror:8 row_mask:0xf bank_mask:0x3
  v_mov_b32_dpp v43, v23 quad_perm:[0,1,2,3] row_mask:0xf bank_mask:0xc
  v_mov_b32_dpp v43, v23 row_ror:8 row_mask:0xf bank_mask:0x3
  v_perm_b32 v204, v176, v172, s50
  v_perm_b32 v205, v184, v180, s50
  v_perm_b32 v206, v192, v188, s50
  v_perm_b32 v207, v200, v196, s50
  v_perm_b32 v208, v176, v172, s51
  v_perm_b32 v209, v184, v180, s51
  v_perm_b32 v210, v192, v188, s51
  v_perm_b32 v211, v200, v196, s51
  v_mfma_f32_16x16x32_bf16 v[44:47], v[204:207], v[40:43], v[44:47]
  v_perm_b32 v204, v177, v173, s50
  v_perm_b32 v205, v185, v181, s50
  v_perm_b32 v206, v193, v189, s50
  v_perm_b32 v207, v201, v197, s50
  v_mfma_f32_16x16x32_bf16 v[48:51], v[208:211], v[40:43], v[48:51]
  v_perm_b32 v208, v177, v173, s51
  v_perm_b32 v209, v185, v181, s51
  v_perm_b32 v210, v193, v189, s51
  v_perm_b32 v211, v201, v197, s51
  v_mfma_f32_16x16x32_bf16 v[52:55], v[204:207], v[40:43], v[52:55]
  v_perm_b32 v204, v178, v174, s50
  v_perm_b32 v205, v186, v182, s50
  v_perm_b32 v206, v194, v190, s50
  v_perm_b32 v207, v202, v198, s50
  v_mfma_f32_16x16x32_bf16 v[56:59], v[208:211], v[40:43], v[56:59]
  v_perm_b32 v208, v178, v174, s51
  v_perm_b32 v209, v186, v182, s51
  v_perm_b32 v210, v194, v190, s51
  v_perm_b32 v211, v202, v198, s51
  v_mfma_f32_16x16x32_bf16 v[60:63], v[204:207], v[40:43], v[60:63]
  v_perm_b32 v204, v179, v175, s50
  v_perm_b32 v205, v187, v183, s50
  v_perm_b32 v206, v195, v191, s50
  v_perm_b32 v207, v203, v199, s50
  v_mfma_f32_16x16x32_bf16 v[64:67], v[208:211], v[40:43], v[64:67]
  v_perm_b32 v208, v179, v175, s51
  v_perm_b32 v209, v187, v183, s51
  v_perm_b32 v210, v195, v191, s51
  v_perm_b32 v211, v203, v199, s51
  v_mfma_f32_16x16x32_bf16 v[68:71], v[204:207], v[40:43], v[68:71]
  s_nop 1
  v_mfma_f32_16x16x32_bf16 v[72:75], v[208:211], v[40:43], v[72:75]
  s_waitcnt vmcnt(16)
  s_lshl_b32 s54, s62, 18
  buffer_load_dwordx4 v[172:175], v1, s[16:19], s54 offen
  s_add_u32 s54, s54, 8192
  buffer_load_dwordx4 v[176:179], v1, s[16:19], s54 offen
  s_add_u32 s54, s54, 8192
  buffer_load_dwordx4 v[180:183], v1, s[16:19], s54 offen
  s_add_u32 s54, s54, 8192
  buffer_load_dwordx4 v[184:187], v1, s[16:19], s54 offen
  s_add_u32 s54, s54, 8192
  buffer_load_dwordx4 v[188:191], v1, s[16:19], s54 offen
  s_add_u32 s54, s54, 8192
  buffer_load_dwordx4 v[192:195], v1, s[16:19], s54 offen
  s_add_u32 s54, s54, 8192
  buffer_load_dwordx4 v[196:199], v1, s[16:19], s54 offen
  s_add_u32 s54, s54, 8192
  buffer_load_dwordx4 v[200:203], v1, s[16:19], s54 offen
  s_add_u32 s62, s62, 1
  s_cmp_eq_u32 s62, 9
  s_cselect_b32 s62, 0, s62
  v_mov_b32_dpp v36, v24 quad_perm:[0,1,2,3] row_mask:0xf bank_mask:0x3
  v_mov_b32_dpp v36, v24 row_ror:8 row_mask:0xf bank_mask:0xc
  v_mov_b32_dpp v37, v25 quad_perm:[0,1,2,3] row_mask:0xf bank_mask:0x3
  v_mov_b32_dpp v37, v25 row_ror:8 row_mask:0xf bank_mask:0xc
  v_mov_b32_dpp v38, v26 quad_perm:[0,1,2,3] row_mask:0xf bank_mask:0x3
  v_mov_b32_dpp v38, v26 row_ror:8 row_mask:0xf bank_mask:0xc
  v_mov_b32_dpp v39, v27 quad_perm:[0,1,2,3] row_mask:0xf bank_mask:0x3
  v_mov_b32_dpp v39, v27 row_ror:8 row_mask:0xf bank_mask:0xc
  v_perm_b32 v204, v80, v76, s50
  v_perm_b32 v205, v88, v84, s50
  v_perm_b32 v206, v96, v92, s50
  v_perm_b32 v207, v104, v100, s50
  v_perm_b32 v208, v80, v76, s51
  v_perm_b32 v209, v88, v84, s51
  v_perm_b32 v210, v96, v92, s51
  v_perm_b32 v211, v104, v100, s51
  v_mfma_f32_16x16x32_bf16 v[44:47], v[204:207], v[36:39], v[44:47]
  v_perm_b32 v204, v81, v77, s50
  v_perm_b32 v205, v89, v85, s50
  v_perm_b32 v206, v97, v93, s50
  v_perm_b32 v207, v105, v101, s50
  v_mfma_f32_16x16x32_bf16 v[48:51], v[208:211], v[36:39], v[48:51]
  v_perm_b32 v208, v81, v77, s51
  v_perm_b32 v209, v89, v85, s51
  v_perm_b32 v210, v97, v93, s51
  v_perm_b32 v211, v105, v101, s51
  v_mfma_f32_16x16x32_bf16 v[52:55], v[204:207], v[36:39], v[52:55]
  v_perm_b32 v204, v82, v78, s50
  v_perm_b32 v205, v90, v86, s50
  v_perm_b32 v206, v98, v94, s50
  v_perm_b32 v207, v106, v102, s50
  v_mfma_f32_16x16x32_bf16 v[56:59], v[208:211], v[36:39], v[56:59]
  v_perm_b32 v208, v82, v78, s51
  v_perm_b32 v209, v90, v86, s51
  v_perm_b32 v210, v98, v94, s51
  v_perm_b32 v211, v106, v102, s51
  v_mfma_f32_16x16x32_bf16 v[60:63], v[204:207], v[36:39], v[60:63]
  v_perm_b32 v204, v83, v79, s50
  v_perm_b32 v205, v91, v87, s50
  v_perm_b32 v206, v99, v95, s50
  v_perm_b32 v207, v107, v103, s50
  v_mfma_f32_16x16x32_bf16 v[64:67], v[208:211], v[36:39], v[64:67]
  v_perm_b32 v208, v83, v79, s51
  v_perm_b32 v209, v91, v87, s51
  v_perm_b32 v210, v99, v95, s51
  v_perm_b32 v211, v107, v103, s51
  v_mfma_f32_16x16x32_bf16 v[68:71], v[204:207], v[36:39], v[68:71]
  s_nop 1
  v_mfma_f32_16x16x32_bf16 v[72:75], v[208:211], v[36:39], v[72:75]
  s_waitcnt vmcnt(16)
  s_lshl_b32 s54, s62, 18
  buffer_load_dwordx4 v[76:79], v1, s[16:19], s54 offen
  s_add_u32 s54, s54, 8192
  buffer_load_dwordx4 v[80:83], v1, s[16:19], s54 offen
  s_add_u32 s54, s54, 8192
  buffer_load_dwordx4 v[84:87], v1, s[16:19], s54 offen
  s_add_u32 s54, s54, 8192
  buffer_load_dwordx4 v[88:91], v1, s[16:19], s54 offen
  s_add_u32 s54, s54, 8192
  buffer_load_dwordx4 v[92:95], v1, s[16:19], s54 offen
  s_add_u32 s54, s54, 8192
  buffer_load_dwordx4 v[96:99], v1, s[16:19], s54 offen
  s_add_u32 s54, s54, 8192
  buffer_load_dwordx4 v[100:103], v1, s[16:19], s54 offen
  s_add_u32 s54, s54, 8192
  buffer_load_dwordx4 v[104:107], v1, s[16:19], s54 offen
  s_barrier
  v_mov_b32_dpp v40, v24 quad_perm:[0,1,2,3] row_mask:0xf bank_mask:0xc
  v_mov_b32_dpp v40, v24 row_ror:8 row_mask:0xf bank_mask:0x3
  v_mov_b32_dpp v41, v25 quad_perm:[0,1,2,3] row_mask:0xf bank_mask:0xc
  v_mov_b32_dpp v41, v25 row_ror:8 row_mask:0xf bank_mask:0x3
  v_mov_b32_dpp v42, v26 quad_perm:[0,1,2,3] row_mask:0xf bank_mask:0xc
  v_mov_b32_dpp v42, v26 row_ror:8 row_mask:0xf bank_mask:0x3
  v_mov_b32_dpp v43, v27 quad_perm:[0,1,2,3] row_mask:0xf bank_mask:0xc
  v_mov_b32_dpp v43, v27 row_ror:8 row_mask:0xf bank_mask:0x3
  v_perm_b32 v204, v112, v108, s50
  v_perm_b32 v205, v120, v116, s50
  v_perm_b32 v206, v128, v124, s50
  v_perm_b32 v207, v136, v132, s50
  v_perm_b32 v208, v112, v108, s51
  v_perm_b32 v209, v120, v116, s51
  v_perm_b32 v210, v128, v124, s51
  v_perm_b32 v211, v136, v132, s51
  v_mfma_f32_16x16x32_bf16 v[44:47], v[204:207], v[40:43], v[44:47]
  v_perm_b32 v204, v113, v109, s50
  v_perm_b32 v205, v121, v117, s50
  v_perm_b32 v206, v129, v125, s50
  v_perm_b32 v207, v137, v133, s50
  v_mfma_f32_16x16x32_bf16 v[48:51], v[208:211], v[40:43], v[48:51]
  v_perm_b32 v208, v113, v109, s51
  v_perm_b32 v209, v121, v117, s51
  v_perm_b32 v210, v129, v125, s51
  v_perm_b32 v211, v137, v133, s51
  v_mfma_f32_16x16x32_bf16 v[52:55], v[204:207], v[40:43], v[52:55]
  v_perm_b32 v204, v114, v110, s50
  v_perm_b32 v205, v122, v118, s50
  v_perm_b32 v206, v130, v126, s50
  v_perm_b32 v207, v138, v134, s50
  v_mfma_f32_16x16x32_bf16 v[56:59], v[208:211], v[40:43], v[56:59]
  v_perm_b32 v208, v114, v110, s51
  v_perm_b32 v209, v122, v118, s51
  v_perm_b32 v210, v130, v126, s51
  v_perm_b32 v211, v138, v134, s51
  v_mfma_f32_16x16x32_bf16 v[60:63], v[204:207], v[40:43], v[60:63]
  v_perm_b32 v204, v115, v111, s50
  v_perm_b32 v205, v123, v119, s50
  v_perm_b32 v206, v131, v127, s50
  v_perm_b32 v207, v139, v135, s50
  v_mfma_f32_16x16x32_bf16 v[64:67], v[208:211], v[40:43], v[64:67]
  v_perm_b32 v208, v115, v111, s51
  v_perm_b32 v209, v123, v119, s51
  v_perm_b32 v210, v131, v127, s51
  v_perm_b32 v211, v139, v135, s51
  v_mfma_f32_16x16x32_bf16 v[68:71], v[204:207], v[40:43], v[68:71]
  s_nop 1
  v_mfma_f32_16x16x32_bf16 v[72:75], v[208:211], v[40:43], v[72:75]
  s_waitcnt vmcnt(16)
  v_mov_b32_dpp v36, v28 quad_perm:[0,1,2,3] row_mask:0xf bank_mask:0x3
  v_mov_b32_dpp v36, v28 row_ror:8 row_mask:0xf bank_mask:0xc
  v_mov_b32_dpp v37, v29 quad_perm:[0,1,2,3] row_mask:0xf bank_mask:0x3
  v_mov_b32_dpp v37, v29 row_ror:8 row_mask:0xf bank_mask:0xc
  v_mov_b32_dpp v38, v30 quad_perm:[0,1,2,3] row_mask:0xf bank_mask:0x3
  v_mov_b32_dpp v38, v30 row_ror:8 row_mask:0xf bank_mask:0xc
  v_mov_b32_dpp v39, v31 quad_perm:[0,1,2,3] row_mask:0xf bank_mask:0x3
  v_mov_b32_dpp v39, v31 row_ror:8 row_mask:0xf bank_mask:0xc
  v_perm_b32 v204, v144, v140, s50
  v_perm_b32 v205, v152, v148, s50
  v_perm_b32 v206, v160, v156, s50
  v_perm_b32 v207, v168, v164, s50
  v_perm_b32 v208, v144, v140, s51
  v_perm_b32 v209, v152, v148, s51
  v_perm_b32 v210, v160, v156, s51
  v_perm_b32 v211, v168, v164, s51
  v_mfma_f32_16x16x32_bf16 v[44:47], v[204:207], v[36:39], v[44:47]
  v_perm_b32 v204, v145, v141, s50
  v_perm_b32 v205, v153, v149, s50
  v_perm_b32 v206, v161, v157, s50
  v_perm_b32 v207, v169, v165, s50
  v_mfma_f32_16x16x32_bf16 v[48:51], v[208:211], v[36:39], v[48:51]
  v_perm_b32 v208, v145, v141, s51
  v_perm_b32 v209, v153, v149, s51
  v_perm_b32 v210, v161, v157, s51
  v_perm_b32 v211, v169, v165, s51
  v_mfma_f32_16x16x32_bf16 v[52:55], v[204:207], v[36:39], v[52:55]
  v_perm_b32 v204, v146, v142, s50
  v_perm_b32 v205, v154, v150, s50
  v_perm_b32 v206, v162, v158, s50
  v_perm_b32 v207, v170, v166, s50
  v_mfma_f32_16x16x32_bf16 v[56:59], v[208:211], v[36:39], v[56:59]
  v_perm_b32 v208, v146, v142, s51
  v_perm_b32 v209, v154, v150, s51
  v_perm_b32 v210, v162, v158, s51
  v_perm_b32 v211, v170, v166, s51
  v_mfma_f32_16x16x32_bf16 v[60:63], v[204:207], v[36:39], v[60:63]
  v_perm_b32 v204, v147, v143, s50
  v_perm_b32 v205, v155, v151, s50
  v_perm_b32 v206, v163, v159, s50
  v_perm_b32 v207, v171, v167, s50
  v_mfma_f32_16x16x32_bf16 v[64:67], v[208:211], v[36:39], v[64:67]
  v_perm_b32 v208, v147, v143, s51
  v_perm_b32 v209, v155, v151, s51
  v_perm_b32 v210, v163, v159, s51
  v_perm_b32 v211, v171, v167, s51
  v_mfma_f32_16x16x32_bf16 v[68:71], v[204:207], v[36:39], v[68:71]
  s_nop 1
  v_mfma_f32_16x16x32_bf16 v[72:75], v[208:211], v[36:39], v[72:75]
  s_waitcnt vmcnt(8)
  v_mov_b32_dpp v40, v28 quad_perm:[0,1,2,3] row_mask:0xf bank_mask:0xc
  v_mov_b32_dpp v40, v28 row_ror:8 row_mask:0xf bank_mask:0x3
  v_mov_b32_dpp v41, v29 quad_perm:[0,1,2,3] row_mask:0xf bank_mask:0xc
  v_mov_b32_dpp v41, v29 row_ror:8 row_mask:0xf bank_mask:0x3
  v_mov_b32_dpp v42, v30 quad_perm:[0,1,2,3] row_mask:0xf bank_mask:0xc
  v_mov_b32_dpp v42, v30 row_ror:8 row_mask:0xf bank_mask:0x3
  v_mov_b32_dpp v43, v31 quad_perm:[0,1,2,3] row_mask:0xf bank_mask:0xc
  v_mov_b32_dpp v43, v31 row_ror:8 row_mask:0xf bank_mask:0x3
  v_perm_b32 v204, v176, v172, s50
  v_perm_b32 v205, v184, v180, s50
  v_perm_b32 v206, v192, v188, s50
  v_perm_b32 v207, v200, v196, s50
  v_perm_b32 v208, v176, v172, s51
  v_perm_b32 v209, v184, v180, s51
  v_perm_b32 v210, v192, v188, s51
  v_perm_b32 v211, v200, v196, s51
  v_mfma_f32_16x16x32_bf16 v[44:47], v[204:207], v[40:43], v[44:47]
  v_perm_b32 v204, v177, v173, s50
  v_perm_b32 v205, v185, v181, s50
  v_perm_b32 v206, v193, v189, s50
  v_perm_b32 v207, v201, v197, s50
  v_mfma_f32_16x16x32_bf16 v[48:51], v[208:211], v[40:43], v[48:51]
  v_perm_b32 v208, v177, v173, s51
  v_perm_b32 v209, v185, v181, s51
  v_perm_b32 v210, v193, v189, s51
  v_perm_b32 v211, v201, v197, s51
  v_mfma_f32_16x16x32_bf16 v[52:55], v[204:207], v[40:43], v[52:55]
  v_perm_b32 v204, v178, v174, s50
  v_perm_b32 v205, v186, v182, s50
  v_perm_b32 v206, v194, v190, s50
  v_perm_b32 v207, v202, v198, s50
  v_mfma_f32_16x16x32_bf16 v[56:59], v[208:211], v[40:43], v[56:59]
  v_perm_b32 v208, v178, v174, s51
  v_perm_b32 v209, v186, v182, s51
  v_perm_b32 v210, v194, v190, s51
  v_perm_b32 v211, v202, v198, s51
  v_mfma_f32_16x16x32_bf16 v[60:63], v[204:207], v[40:43], v[60:63]
  v_perm_b32 v204, v179, v175, s50
  v_perm_b32 v205, v187, v183, s50
  v_perm_b32 v206, v195, v191, s50
  v_perm_b32 v207, v203, v199, s50
  v_mfma_f32_16x16x32_bf16 v[64:67], v[208:211], v[40:43], v[64:67]
  v_perm_b32 v208, v179, v175, s51
  v_perm_b32 v209, v187, v183, s51
  v_perm_b32 v210, v195, v191, s51
  v_perm_b32 v211, v203, v199, s51
  v_mfma_f32_16x16x32_bf16 v[68:71], v[204:207], v[40:43], v[68:71]
  s_nop 1
  v_mfma_f32_16x16x32_bf16 v[72:75], v[208:211], v[40:43], v[72:75]
  s_waitcnt vmcnt(0)
  v_mov_b32_dpp v36, v32 quad_perm:[0,1,2,3] row_mask:0xf bank_mask:0x3
  v_mov_b32_dpp v36, v32 row_ror:8 row_mask:0xf bank_mask:0xc
  v_mov_b32_dpp v37, v33 quad_perm:[0,1,2,3] row_mask:0xf bank_mask:0x3
  v_mov_b32_dpp v37, v33 row_ror:8 row_mask:0xf bank_mask:0xc
  v_mov_b32_dpp v38, v34 quad_perm:[0,1,2,3] row_mask:0xf bank_mask:0x3
  v_mov_b32_dpp v38, v34 row_ror:8 row_mask:0xf bank_mask:0xc
  v_mov_b32_dpp v39, v35 quad_perm:[0,1,2,3] row_mask:0xf bank_mask:0x3
  v_mov_b32_dpp v39, v35 row_ror:8 row_mask:0xf bank_mask:0xc
  v_perm_b32 v204, v80, v76, s50
  v_perm_b32 v205, v88, v84, s50
  v_perm_b32 v206, v96, v92, s50
  v_perm_b32 v207, v104, v100, s50
  v_perm_b32 v208, v80, v76, s51
  v_perm_b32 v209, v88, v84, s51
  v_perm_b32 v210, v96, v92, s51
  v_perm_b32 v211, v104, v100, s51
  v_mfma_f32_16x16x32_bf16 v[44:47], v[204:207], v[36:39], v[44:47]
  v_perm_b32 v204, v81, v77, s50
  v_perm_b32 v205, v89, v85, s50
  v_perm_b32 v206, v97, v93, s50
  v_perm_b32 v207, v105, v101, s50
  v_mfma_f32_16x16x32_bf16 v[48:51], v[208:211], v[36:39], v[48:51]
  v_perm_b32 v208, v81, v77, s51
  v_perm_b32 v209, v89, v85, s51
  v_perm_b32 v210, v97, v93, s51
  v_perm_b32 v211, v105, v101, s51
  v_mfma_f32_16x16x32_bf16 v[52:55], v[204:207], v[36:39], v[52:55]
  v_perm_b32 v204, v82, v78, s50
  v_perm_b32 v205, v90, v86, s50
  v_perm_b32 v206, v98, v94, s50
  v_perm_b32 v207, v106, v102, s50
  v_mfma_f32_16x16x32_bf16 v[56:59], v[208:211], v[36:39], v[56:59]
  v_perm_b32 v208, v82, v78, s51
  v_perm_b32 v209, v90, v86, s51
  v_perm_b32 v210, v98, v94, s51
  v_perm_b32 v211, v106, v102, s51
  v_mfma_f32_16x16x32_bf16 v[60:63], v[204:207], v[36:39], v[60:63]
  v_perm_b32 v204, v83, v79, s50
  v_perm_b32 v205, v91, v87, s50
  v_perm_b32 v206, v99, v95, s50
  v_perm_b32 v207, v107, v103, s50
  v_mfma_f32_16x16x32_bf16 v[64:67], v[208:211], v[36:39], v[64:67]
  v_perm_b32 v208, v83, v79, s51
  v_perm_b32 v209, v91, v87, s51
  v_perm_b32 v210, v99, v95, s51
  v_perm_b32 v211, v107, v103, s51
  v_mfma_f32_16x16x32_bf16 v[68:71], v[204:207], v[36:39], v[68:71]
  s_nop 1
  v_mfma_f32_16x16x32_bf16 v[72:75], v[208:211], v[36:39], v[72:75]
  s_nop 0
  v_cndmask_b32 v108, v44, v46, s[60:61]
  v_cndmask_b32 v116, v45, v47, s[60:61]
  v_cndmask_b32 v109, v48, v50, s[60:61]
  v_cndmask_b32 v117, v49, v51, s[60:61]
  v_cndmask_b32 v110, v52, v54, s[60:61]
  v_cndmask_b32 v118, v53, v55, s[60:61]
  v_cndmask_b32 v111, v56, v58, s[60:61]
  v_cndmask_b32 v119, v57, v59, s[60:61]
  v_cndmask_b32 v112, v60, v62, s[60:61]
  v_cndmask_b32 v120, v61, v63, s[60:61]
  v_cndmask_b32 v113, v64, v66, s[60:61]
  v_cndmask_b32 v121, v65, v67, s[60:61]
  v_cndmask_b32 v114, v68, v70, s[60:61]
  v_cndmask_b32 v122, v69, v71, s[60:61]
  v_cndmask_b32 v115, v72, v74, s[60:61]
  v_cndmask_b32 v123, v73, v75, s[60:61]
  ds_write_b128 v7, v[108:111] offset:0
  ds_write_b128 v7, v[112:115] offset:16
  ds_write_b128 v7, v[116:119] offset:32
  ds_write_b128 v7, v[120:123] offset:48
  s_mov_b64 exec, 1
  s_waitcnt lgkmcnt(0)
  ds_add_u32 v8, v9 offset:512
  s_mov_b64 exec, -1
  s_branch L_wo
L_kv:
  s_setprio 1
  v_lshrrev_b32 v11, 1, v14
  v_lshlrev_b32 v11, 10, v11
  v_and_b32 v12, 1, v14
  v_lshlrev_b32 v12, 4, v12
  v_lshlrev_b32 v13, 5, v15
  v_add3_u32 v1, v11, v12, v13
  v_mov_b32 v26, 0
  v_mov_b32 v27, 0
  v_mov_b32 v13, 131072
  v_lshl_add_u32 v12, v0, 2, v13
  ds_write_b64 v13, v[26:27] offset:512
  ds_write_b64 v13, v[26:27] offset:520
  ds_write_b64 v13, v[26:27] offset:528
  ds_write_b32 v12, v26 offset:25888
  s_lshl_b32 s55, s49, 5
  s_add_u32 s55, s55, s48
  s_lshl_b32 s55, s55, 19
  s_and_b32 s56, s49, 12
  s_lshr_b32 s59, 0x64206420, s56
  s_and_b32 s59, s59, 15
  s_mov_b32 s10, 0x880000
  s_mov_b32 s11, 0x00020000
  s_lshl_b32 s54, s3, 13
  s_lshl_b32 s57, s3, 16
  s_lshl_b32 s58, s3, 14
  s_or_b32 s57, s57, s58
  s_and_b32 s57, s57, 0x18000
  s_add_u32 m0, s57, 8192
  s_waitcnt lgkmcnt(0)
  s_add_u32 s8, s34, s55
  s_addc_u32 s9, s35, 0
  s_cmp_eq_u32 s59, 0
  s_cbranch_scc1 L_path0
  buffer_load_dwordx4 v[64:67], v1, s[8:11], s54 offen offset:0 nt
  buffer_load_dwordx4 v[68:71], v1, s[8:11], s54 offen offset:128 nt
  buffer_load_dwordx4 v[72:75], v1, s[8:11], s54 offen offset:256 nt
  buffer_load_dwordx4 v[76:79], v1, s[8:11], s54 offen offset:384 nt
  buffer_load_dwordx4 v[80:83], v1, s[8:11], s54 offen offset:512 nt
  buffer_load_dwordx4 v[84:87], v1, s[8:11], s54 offen offset:640 nt
  buffer_load_dwordx4 v[88:91], v1, s[8:11], s54 offen offset:768 nt
  buffer_load_dwordx4 v[92:95], v1, s[8:11], s54 offen offset:896 nt
  s_add_u32 s54, s54, 0x8000
  buffer_load_dwordx4 v[96:99], v1, s[8:11], s54 offen offset:0 nt
  buffer_load_dwordx4 v[100:103], v1, s[8:11], s54 offen offset:128 nt
  buffer_load_dwordx4 v[104:107], v1, s[8:11], s54 offen offset:256 nt
  buffer_load_dwordx4 v[108:111], v1, s[8:11], s54 offen offset:384 nt
  buffer_load_dwordx4 v[112:115], v1, s[8:11], s54 offen offset:512 nt
  buffer_load_dwordx4 v[116:119], v1, s[8:11], s54 offen offset:640 nt
  buffer_load_dwordx4 v[120:123], v1, s[8:11], s54 offen offset:768 nt
  buffer_load_dwordx4 v[124:127], v1, s[8:11], s54 offen offset:896 nt
  s_add_u32 s54, s54, 0x8000
  s_cmp_eq_u32 s59, 2
  s_cbranch_scc1 L_path2
  buffer_load_dwordx4 v[128:131], v1, s[8:11], s54 offen offset:0 nt
  buffer_load_dwordx4 v[132:135], v1, s[8:11], s54 offen offset:128 nt
  buffer_load_dwordx4 v[136:139], v1, s[8:11], s54 offen offset:256 nt
  buffer_load_dwordx4 v[140:143], v1, s[8:11], s54 offen offset:384 nt
  buffer_load_dwordx4 v[144:147], v1, s[8:11], s54 offen offset:512 nt
  buffer_load_dwordx4 v[148:151], v1, s[8:11], s54 offen offset:640 nt
  buffer_load_dwordx4 v[152:155], v1, s[8:11], s54 offen offset:768 nt
  buffer_load_dwordx4 v[156:159], v1, s[8:11], s54 offen offset:896 nt
  s_add_u32 s54, s54, 0x8000
  buffer_load_dwordx4 v[160:163], v1, s[8:11], s54 offen offset:0 nt
  buffer_load_dwordx4 v[164:167], v1, s[8:11], s54 offen offset:128 nt
  buffer_load_dwordx4 v[168:171], v1, s[8:11], s54 offen offset:256 nt
  buffer_load_dwordx4 v[172:175], v1, s[8:11], s54 offen offset:384 nt
  buffer_load_dwordx4 v[176:179], v1, s[8:11], s54 offen offset:512 nt
  buffer_load_dwordx4 v[180:183], v1, s[8:11], s54 offen offset:640 nt
  buffer_load_dwordx4 v[184:187], v1, s[8:11], s54 offen offset:768 nt
  buffer_load_dwordx4 v[188:191], v1, s[8:11], s54 offen offset:896 nt
  s_add_u32 s54, s54, 0x8000
  s_cmp_eq_u32 s59, 4
  s_cbranch_scc1 L_path4
  buffer_load_dwordx4 v[32:35], v1, s[8:11], s54 offen offset:0 nt
  buffer_load_dwordx4 v[36:39], v1, s[8:11], s54 offen offset:128 nt
  buffer_load_dwordx4 v[40:43], v1, s[8:11], s54 offen offset:256 nt
  buffer_load_dwordx4 v[44:47], v1, s[8:11], s54 offen offset:384 nt
  buffer_load_dwordx4 v[48:51], v1, s[8:11], s54 offen offset:512 nt
  buffer_load_dwordx4 v[52:55], v1, s[8:11], s54 offen offset:640 nt
  buffer_load_dwordx4 v[56:59], v1, s[8:11], s54 offen offset:768 nt
  buffer_load_dwordx4 v[60:63], v1, s[8:11], s54 offen offset:896 nt
  s_add_u32 s54, s54, 0x8000
  buffer_load_dwordx4 v1, s[8:11], s54 offen offset:0 nt lds
  s_add_u32 m0, m0, 896
  s_nop 0
  buffer_load_dwordx4 v1, s[8:11], s54 offen offset:128 nt lds
  s_add_u32 m0, m0, 896
  s_nop 0
  buffer_load_dwordx4 v1, s[8:11], s54 offen offset:256 nt lds
  s_add_u32 m0, m0, 896
  s_nop 0
  buffer_load_dwordx4 v1, s[8:11], s54 offen offset:384 nt lds
  s_add_u32 m0, m0, 896
  s_nop 0
  buffer_load_dwordx4 v1, s[8:11], s54 offen offset:512 nt lds
  s_add_u32 m0, m0, 896
  s_nop 0
  buffer_load_dwordx4 v1, s[8:11], s54 offen offset:640 nt lds
  s_add_u32 m0, m0, 896
  s_nop 0
  buffer_load_dwordx4 v1, s[8:11], s54 offen offset:768 nt lds
  s_add_u32 m0, m0, 896
  s_nop 0
  buffer_load_dwordx4 v1, s[8:11], s54 offen offset:896 nt lds
  s_add_u32 m0, m0, 1920
  s_add_u32 s54, s54, 0x8000
L_path6:
  s_barrier
  s_add_u32 s12, s36, s55
  s_addc_u32 s13, s37, 0
  s_mov_b32 s14, 0x880000
  s_mov_b32 s15, 0x00020000
  s_setprio 2
  s_cmp_ge_u32 s3, 2
  s_cbranch_scc1 L_pr6
  s_setprio 3
L_pr6:
  s_mov_b32 s50, 0x05040100
  s_mov_b32 s51, 0x07060302
  s_mov_b32 s60, 0xff00ff00
  s_mov_b32 s61, 0xff00ff00
  s_mov_b32 s7, 2
  s_mov_b32 s6, -32
  s_mov_b32 s27, 0
  s_mov_b32 s52, 0x3e0293ee
  v_lshlrev_b32 v192, 11, v15
  v_lshl_add_u32 v2, v14, 4, v192
  v_lshrrev_b32 v195, 3, v0
  v_and_b32 v193, 3, v14
  v_mul_u32_u24 v192, 1040, v193
  v_bfe_u32 v194, v14, 2, 1
  v_lshl_add_u32 v192, v194, 9, v192
  v_lshl_add_u32 v192, v195, 5, v192
  v_add_u32 v3, 140320, v192
  v_mul_u32_u24 v192, 544, v193
  v_lshl_add_u32 v192, v194, 8, v192
  v_lshl_add_u32 v192, v195, 5, v192
  s_mul_i32 s55, s3, 2176
  s_add_u32 s58, s55, 131616
  v_add_u32 v6, s58, v192
  v_lshlrev_b32 v192, 4, v0
  v_add_u32 v28, s57, v192
  v_add_u32 v4, 8192, v28
  v_and_b32 v194, 7, v14
  v_lshl_add_u32 v7, v194, 5, v13
  s_lshl_b32 s55, s3, 3
  v_add_u32 v5, s55, v7
  v_mov_b32 v25, 131072
  s_lshl_b32 s55, s3, 2
  v_add_u32 v29, s55, v13
  v_mov_b32 v8, 0xf149f2ca
  v_mov_b32 v9, 0
  v_mov_b32 v24, 0xf149f2ca
  s_barrier
  buffer_load_dwordx4 v1, s[8:11], s54 offen offset:0 nt lds
  s_add_u32 m0, m0, 896
  s_nop 0
  buffer_load_dwordx4 v1, s[8:11], s54 offen offset:128 nt lds
  s_add_u32 m0, m0, 896
  s_nop 0
  buffer_load_dwordx4 v1, s[8:11], s54 offen offset:256 nt lds
  s_add_u32 m0, m0, 896
  s_nop 0
  buffer_load_dwordx4 v1, s[8:11], s54 offen offset:384 nt lds
  s_add_u32 m0, m0, 896
  s_nop 0
  buffer_load_dwordx4 v1, s[8:11], s54 offen offset:512 nt lds
  s_add_u32 m0, m0, 896
  s_nop 0
  buffer_load_dwordx4 v1, s[8:11], s54 offen offset:640 nt lds
  s_add_u32 m0, m0, 896
  s_nop 0
  buffer_load_dwordx4 v1, s[8:11], s54 offen offset:768 nt lds
  s_add_u32 m0, m0, 896
  s_nop 0
  buffer_load_dwordx4 v1, s[8:11], s54 offen offset:896 nt lds
  s_add_u32 m0, m0, 1920
  s_add_u32 s54, s54, 0x8000
  s_waitcnt vmcnt(55)
  buffer_load_dwordx4 v1, s[8:11], s54 offen offset:0 nt lds
  s_add_u32 m0, m0, 896
  s_nop 0
  buffer_load_dwordx4 v1, s[8:11], s54 offen offset:128 nt lds
  s_add_u32 m0, m0, 896
  s_nop 0
  buffer_load_dwordx4 v1, s[8:11], s54 offen offset:256 nt lds
  s_add_u32 m0, m0, 896
  s_nop 0
  buffer_load_dwordx4 v1, s[8:11], s54 offen offset:384 nt lds
  s_add_u32 m0, m0, 896
  s_nop 0
  buffer_load_dwordx4 v1, s[8:11], s54 offen offset:512 nt lds
  s_add_u32 m0, m0, 896
  s_nop 0
  buffer_load_dwordx4 v1, s[8:11], s54 offen offset:640 nt lds
  s_add_u32 m0, m0, 896
  s_nop 0
  buffer_load_dwordx4 v1, s[8:11], s54 offen offset:768 nt lds
  s_add_u32 m0, m0, 896
  s_nop 0
  buffer_load_dwordx4 v1, s[8:11], s54 offen offset:896 nt lds
  s_add_u32 m0, m0, 1920
  s_add_u32 s54, s54, 0x8000
L_wq6:
  ds_read_b32 v11, v13 offset:512
  s_waitcnt lgkmcnt(0)
  v_readfirstlane_b32 s55, v11
  s_cmp_ge_u32 s55, 4
  s_cbranch_scc1 L_wq6_d
  s_sleep 1
  s_branch L_wq6
L_wq6_d:
  ds_read_b128 v[192:195], v3 offset:0
  ds_read_b128 v[196:199], v3 offset:16
  ds_read_b128 v[200:203], v3 offset:8320
  ds_read_b128 v[204:207], v3 offset:8336
  ds_read_b128 v[208:211], v3 offset:256
  ds_read_b128 v[212:215], v3 offset:272
  ds_read_b128 v[216:219], v3 offset:8576
  ds_read_b128 v[220:223], v3 offset:8592
  s_waitcnt lgkmcnt(4)
  v_pk_add_f32 v[192:193], v[192:193], v[200:201]
  v_pk_add_f32 v[194:195], v[194:195], v[202:203]
  v_pk_add_f32 v[196:197], v[196:197], v[204:205]
  v_pk_add_f32 v[198:199], v[198:199], v[206:207]
  v_cvt_pk_bf16_f32 v16, v192, v193
  v_cvt_pk_bf16_f32 v17, v194, v195
  v_cvt_pk_bf16_f32 v18, v196, v197
  v_cvt_pk_bf16_f32 v19, v198, v199
  s_waitcnt lgkmcnt(0)
  v_pk_add_f32 v[208:209], v[208:209], v[216:217]
  v_pk_add_f32 v[210:211], v[210:211], v[218:219]
  v_pk_add_f32 v[212:213], v[212:213], v[220:221]
  v_pk_add_f32 v[214:215], v[214:215], v[222:223]
  v_cvt_pk_bf16_f32 v20, v208, v209
  v_cvt_pk_bf16_f32 v21, v210, v211
  v_cvt_pk_bf16_f32 v22, v212, v213
  v_cvt_pk_bf16_f32 v23, v214, v215
  s_waitcnt vmcnt(16)
  ds_read_b128 v[192:195], v28 offset:8192
  ds_read_b128 v[200:203], v28 offset:10240
  ds_read_b128 v[208:211], v28 offset:12288
  ds_read_b128 v[216:219], v28 offset:14336
  ds_read_b128 v[196:199], v28 offset:9216
  ds_read_b128 v[204:207], v28 offset:11264
  ds_read_b128 v[212:215], v28 offset:13312
  ds_read_b128 v[220:223], v28 offset:15360
  v_mfma_f32_16x16x32_bf16 v[224:227], v[64:67], v[16:19], 0
  v_mfma_f32_16x16x32_bf16 v[228:231], v[72:75], v[16:19], 0
  v_mfma_f32_16x16x32_bf16 v[232:235], v[80:83], v[16:19], 0
  v_mfma_f32_16x16x32_bf16 v[236:239], v[88:91], v[16:19], 0
  v_mfma_f32_16x16x32_bf16 v[224:227], v[68:71], v[20:23], v[224:227]
  v_mfma_f32_16x16x32_bf16 v[228:231], v[76:79], v[20:23], v[228:231]
  v_mfma_f32_16x16x32_bf16 v[232:235], v[84:87], v[20:23], v[232:235]
  v_mfma_f32_16x16x32_bf16 v[236:239], v[92:95], v[20:23], v[236:239]
  s_cmp_ge_u32 s3, 2
  s_cbranch_scc1 L_ni6_1
  buffer_load_dwordx4 v[64:67], v1, s[8:11], s54 offen offset:0 nt
  buffer_load_dwordx4 v[68:71], v1, s[8:11], s54 offen offset:128 nt
  buffer_load_dwordx4 v[72:75], v1, s[8:11], s54 offen offset:256 nt
  buffer_load_dwordx4 v[76:79], v1, s[8:11], s54 offen offset:384 nt
  buffer_load_dwordx4 v[80:83], v1, s[8:11], s54 offen offset:512 nt
  buffer_load_dwordx4 v[84:87], v1, s[8:11], s54 offen offset:640 nt
  buffer_load_dwordx4 v[88:91], v1, s[8:11], s54 offen offset:768 nt
  buffer_load_dwordx4 v[92:95], v1, s[8:11], s54 offen offset:896 nt
  s_add_u32 s54, s54, 0x4000
  s_bitcmp1_b32 s54, 19
  s_cselect_b32 s55, 0x880000, 0
  s_xor_b32 s54, s54, s55
L_ni6_1:
  s_nop 2
  v_add_f32_dpp v252, v225, v224 row_ror:8 row_mask:0xf bank_mask:0x3
  v_add_f32_dpp v252, v226, v227 row_ror:8 row_mask:0xf bank_mask:0xc
  v_add_f32_dpp v253, v229, v228 row_ror:8 row_mask:0xf bank_mask:0x3
  v_add_f32_dpp v253, v230, v231 row_ror:8 row_mask:0xf bank_mask:0xc
  v_add_f32_dpp v254, v233, v232 row_ror:8 row_mask:0xf bank_mask:0x3
  v_add_f32_dpp v254, v234, v235 row_ror:8 row_mask:0xf bank_mask:0xc
  v_add_f32_dpp v255, v237, v236 row_ror:8 row_mask:0xf bank_mask:0x3
  v_add_f32_dpp v255, v238, v239 row_ror:8 row_mask:0xf bank_mask:0xc
  ds_write_b128 v28, v[252:255] offset:0
  v_max3_f32 v11, v252, v253, v24
  v_max3_f32 v24, v254, v255, v11
  v_mul_f32 v11, s52, v24
  v_sub_f32 v10, v8, v11
  v_exp_f32 v10, v10
  v_mov_b32 v8, v11
  v_fma_f32 v240, v252, s52, -v11
  v_fma_f32 v241, v253, s52, -v11
  v_fma_f32 v242, v254, s52, -v11
  v_fma_f32 v243, v255, s52, -v11
  v_exp_f32 v240, v240
  v_exp_f32 v241, v241
  v_exp_f32 v242, v242
  v_exp_f32 v243, v243
  v_fma_f32 v9, v9, v10, v240
  v_add_f32 v11, v241, v242
  v_add_f32 v9, v9, v243
  v_add_f32 v9, v9, v11
  v_mfma_f32_16x16x32_bf16 v[224:227], v[96:99], v[16:19], 0
  v_mfma_f32_16x16x32_bf16 v[228:231], v[104:107], v[16:19], 0
  v_mfma_f32_16x16x32_bf16 v[232:235], v[112:115], v[16:19], 0
  v_mfma_f32_16x16x32_bf16 v[236:239], v[120:123], v[16:19], 0
  v_mfma_f32_16x16x32_bf16 v[224:227], v[100:103], v[20:23], v[224:227]
  v_mfma_f32_16x16x32_bf16 v[228:231], v[108:111], v[20:23], v[228:231]
  v_mfma_f32_16x16x32_bf16 v[232:235], v[116:119], v[20:23], v[232:235]
  v_mfma_f32_16x16x32_bf16 v[236:239], v[124:127], v[20:23], v[236:239]
  s_cmp_ge_u32 s3, 2
  s_cbranch_scc1 L_ni6_2
  buffer_load_dwordx4 v[96:99], v1, s[8:11], s54 offen offset:0 nt
  buffer_load_dwordx4 v[100:103], v1, s[8:11], s54 offen offset:128 nt
  buffer_load_dwordx4 v[104:107], v1, s[8:11], s54 offen offset:256 nt
  buffer_load_dwordx4 v[108:111], v1, s[8:11], s54 offen offset:384 nt
  buffer_load_dwordx4 v[112:115], v1, s[8:11], s54 offen offset:512 nt
  buffer_load_dwordx4 v[116:119], v1, s[8:11], s54 offen offset:640 nt
  buffer_load_dwordx4 v[120:123], v1, s[8:11], s54 offen offset:768 nt
  buffer_load_dwordx4 v[124:127], v1, s[8:11], s54 offen offset:896 nt
  s_add_u32 s54, s54, 0x4000
  s_bitcmp1_b32 s54, 19
  s_cselect_b32 s55, 0x880000, 0
  s_xor_b32 s54, s54, s55
L_ni6_2:
  s_nop 2
  v_add_f32_dpp v252, v225, v224 row_ror:8 row_mask:0xf bank_mask:0x3
  v_add_f32_dpp v252, v226, v227 row_ror:8 row_mask:0xf bank_mask:0xc
  v_add_f32_dpp v253, v229, v228 row_ror:8 row_mask:0xf bank_mask:0x3
  v_add_f32_dpp v253, v230, v231 row_ror:8 row_mask:0xf bank_mask:0xc
  v_add_f32_dpp v254, v233, v232 row_ror:8 row_mask:0xf bank_mask:0x3
  v_add_f32_dpp v254, v234, v235 row_ror:8 row_mask:0xf bank_mask:0xc
  v_add_f32_dpp v255, v237, v236 row_ror:8 row_mask:0xf bank_mask:0x3
  v_add_f32_dpp v255, v238, v239 row_ror:8 row_mask:0xf bank_mask:0xc
  ds_write_b128 v28, v[252:255] offset:1024
  v_max3_f32 v11, v252, v253, v24
  v_max3_f32 v24, v254, v255, v11
  v_mul_f32 v11, s52, v24
  v_sub_f32 v10, v8, v11
  v_exp_f32 v10, v10
  v_mov_b32 v8, v11
  v_fma_f32 v240, v252, s52, -v11
  v_fma_f32 v241, v253, s52, -v11
  v_fma_f32 v242, v254, s52, -v11
  v_fma_f32 v243, v255, s52, -v11
  v_exp_f32 v240, v240
  v_exp_f32 v241, v241
  v_exp_f32 v242, v242
  v_exp_f32 v243, v243
  v_fma_f32 v9, v9, v10, v240
  v_add_f32 v11, v241, v242
  v_add_f32 v9, v9, v243
  v_add_f32 v9, v9, v11
  s_waitcnt lgkmcnt(0)
  v_mfma_f32_16x16x32_bf16 v[224:227], v[192:195], v[16:19], 0
  v_mfma_f32_16x16x32_bf16 v[228:231], v[200:203], v[16:19], 0
  v_mfma_f32_16x16x32_bf16 v[232:235], v[208:211], v[16:19], 0
  v_mfma_f32_16x16x32_bf16 v[236:239], v[216:219], v[16:19], 0
  v_mfma_f32_16x16x32_bf16 v[224:227], v[196:199], v[20:23], v[224:227]
  v_mfma_f32_16x16x32_bf16 v[228:231], v[204:207], v[20:23], v[228:231]
  v_mfma_f32_16x16x32_bf16 v[232:235], v[212:215], v[20:23], v[232:235]
  v_mfma_f32_16x16x32_bf16 v[236:239], v[220:223], v[20:23], v[236:239]
  s_nop 4
  v_add_f32_dpp v252, v225, v224 row_ror:8 row_mask:0xf bank_mask:0x3
  v_add_f32_dpp v252, v226, v227 row_ror:8 row_mask:0xf bank_mask:0xc
  v_add_f32_dpp v253, v229, v228 row_ror:8 row_mask:0xf bank_mask:0x3
  v_add_f32_dpp v253, v230, v231 row_ror:8 row_mask:0xf bank_mask:0xc
  v_add_f32_dpp v254, v233, v232 row_ror:8 row_mask:0xf bank_mask:0x3
  v_add_f32_dpp v254, v234, v235 row_ror:8 row_mask:0xf bank_mask:0xc
  v_add_f32_dpp v255, v237, v236 row_ror:8 row_mask:0xf bank_mask:0x3
  v_add_f32_dpp v255, v238, v239 row_ror:8 row_mask:0xf bank_mask:0xc
  ds_write_b128 v28, v[252:255] offset:5120
  v_max3_f32 v11, v252, v253, v24
  v_max3_f32 v24, v254, v255, v11
  v_mul_f32 v11, s52, v24
  v_sub_f32 v10, v8, v11
  v_exp_f32 v10, v10
  v_mov_b32 v8, v11
  v_fma_f32 v240, v252, s52, -v11
  v_fma_f32 v241, v253, s52, -v11
  v_fma_f32 v242, v254, s52, -v11
  v_fma_f32 v243, v255, s52, -v11
  v_exp_f32 v240, v240
  v_exp_f32 v241, v241
  v_exp_f32 v242, v242
  v_exp_f32 v243, v243
  v_fma_f32 v9, v9, v10, v240
  v_add_f32 v11, v241, v242
  v_add_f32 v9, v9, v243
  v_add_f32 v9, v9, v11
  v_mfma_f32_16x16x32_bf16 v[224:227], v[128:131], v[16:19], 0
  v_mfma_f32_16x16x32_bf16 v[228:231], v[136:139], v[16:19], 0
  v_mfma_f32_16x16x32_bf16 v[232:235], v[144:147], v[16:19], 0
  v_mfma_f32_16x16x32_bf16 v[236:239], v[152:155], v[16:19], 0
  v_mfma_f32_16x16x32_bf16 v[224:227], v[132:135], v[20:23], v[224:227]
  v_mfma_f32_16x16x32_bf16 v[228:231], v[140:143], v[20:23], v[228:231]
  v_mfma_f32_16x16x32_bf16 v[232:235], v[148:151], v[20:23], v[232:235]
  v_mfma_f32_16x16x32_bf16 v[236:239], v[156:159], v[20:23], v[236:239]
  s_nop 4
  v_add_f32_dpp v252, v225, v224 row_ror:8 row_mask:0xf bank_mask:0x3
  v_add_f32_dpp v252, v226, v227 row_ror:8 row_mask:0xf bank_mask:0xc
  v_add_f32_dpp v253, v229, v228 row_ror:8 row_mask:0xf bank_mask:0x3
  v_add_f32_dpp v253, v230, v231 row_ror:8 row_mask:0xf bank_mask:0xc
  v_add_f32_dpp v254, v233, v232 row_ror:8 row_mask:0xf bank_mask:0x3
  v_add_f32_dpp v254, v234, v235 row_ror:8 row_mask:0xf bank_mask:0xc
  v_add_f32_dpp v255, v237, v236 row_ror:8 row_mask:0xf bank_mask:0x3
  v_add_f32_dpp v255, v238, v239 row_ror:8 row_mask:0xf bank_mask:0xc
  ds_write_b128 v28, v[252:255] offset:2048
  v_max3_f32 v11, v252, v253, v24
  v_max3_f32 v24, v254, v255, v11
  v_mul_f32 v11, s52, v24
  v_sub_f32 v10, v8, v11
  v_exp_f32 v10, v10
  v_mov_b32 v8, v11
  v_fma_f32 v240, v252, s52, -v11
  v_fma_f32 v241, v253, s52, -v11
  v_fma_f32 v242, v254, s52, -v11
  v_fma_f32 v243, v255, s52, -v11
  v_exp_f32 v240, v240
  v_exp_f32 v241, v241
  v_exp_f32 v242, v242
  v_exp_f32 v243, v243
  v_fma_f32 v9, v9, v10, v240
  v_add_f32 v11, v241, v242
  v_add_f32 v9, v9, v243
  v_add_f32 v9, v9, v11
  s_cmp_lt_u32 s3, 2
  s_cbranch_scc1 L_pw6_3
  s_waitcnt vmcnt(8)
L_pw6_3:
  s_waitcnt vmcnt(24)
  ds_read_b128 v[192:195], v28 offset:16384
  ds_read_b128 v[200:203], v28 offset:18432
  ds_read_b128 v[208:211], v28 offset:20480
  ds_read_b128 v[216:219], v28 offset:22528
  ds_read_b128 v[196:199], v28 offset:17408
  ds_read_b128 v[204:207], v28 offset:19456
  ds_read_b128 v[212:215], v28 offset:21504
  ds_read_b128 v[220:223], v28 offset:23552
  v_mfma_f32_16x16x32_bf16 v[224:227], v[160:163], v[16:19], 0
  v_mfma_f32_16x16x32_bf16 v[228:231], v[168:171], v[16:19], 0
  v_mfma_f32_16x16x32_bf16 v[232:235], v[176:179], v[16:19], 0
  v_mfma_f32_16x16x32_bf16 v[236:239], v[184:187], v[16:19], 0
  v_mfma_f32_16x16x32_bf16 v[224:227], v[164:167], v[20:23], v[224:227]
  v_mfma_f32_16x16x32_bf16 v[228:231], v[172:175], v[20:23], v[228:231]
  v_mfma_f32_16x16x32_bf16 v[232:235], v[180:183], v[20:23], v[232:235]
  v_mfma_f32_16x16x32_bf16 v[236:239], v[188:191], v[20:23], v[236:239]
  s_nop 4
  v_add_f32_dpp v252, v225, v224 row_ror:8 row_mask:0xf bank_mask:0x3
  v_add_f32_dpp v252, v226, v227 row_ror:8 row_mask:0xf bank_mask:0xc
  v_add_f32_dpp v253, v229, v228 row_ror:8 row_mask:0xf bank_mask:0x3
  v_add_f32_dpp v253, v230, v231 row_ror:8 row_mask:0xf bank_mask:0xc
  v_add_f32_dpp v254, v233, v232 row_ror:8 row_mask:0xf bank_mask:0x3
  v_add_f32_dpp v254, v234, v235 row_ror:8 row_mask:0xf bank_mask:0xc
  v_add_f32_dpp v255, v237, v236 row_ror:8 row_mask:0xf bank_mask:0x3
  v_add_f32_dpp v255, v238, v239 row_ror:8 row_mask:0xf bank_mask:0xc
  ds_write_b128 v28, v[252:255] offset:3072
  v_max3_f32 v11, v252, v253, v24
  v_max3_f32 v24, v254, v255, v11
  v_mul_f32 v11, s52, v24
  v_sub_f32 v10, v8, v11
  v_exp_f32 v10, v10
  v_mov_b32 v8, v11
  v_fma_f32 v240, v252, s52, -v11
  v_fma_f32 v241, v253, s52, -v11
  v_fma_f32 v242, v254, s52, -v11
  v_fma_f32 v243, v255, s52, -v11
  v_exp_f32 v240, v240
  v_exp_f32 v241, v241
  v_exp_f32 v242, v242
  v_exp_f32 v243, v243
  v_fma_f32 v9, v9, v10, v240
  v_add_f32 v11, v241, v242
  v_add_f32 v9, v9, v243
  v_add_f32 v9, v9, v11
  s_waitcnt lgkmcnt(0)
  v_mfma_f32_16x16x32_bf16 v[224:227], v[192:195], v[16:19], 0
  v_mfma_f32_16x16x32_bf16 v[228:231], v[200:203], v[16:19], 0
  v_mfma_f32_16x16x32_bf16 v[232:235], v[208:211], v[16:19], 0
  v_mfma_f32_16x16x32_bf16 v[236:239], v[216:219], v[16:19], 0
  v_mfma_f32_16x16x32_bf16 v[224:227], v[196:199], v[20:23], v[224:227]
  v_mfma_f32_16x16x32_bf16 v[228:231], v[204:207], v[20:23], v[228:231]
  v_mfma_f32_16x16x32_bf16 v[232:235], v[212:215], v[20:23], v[232:235]
  v_mfma_f32_16x16x32_bf16 v[236:239], v[220:223], v[20:23], v[236:239]
  s_nop 4
  v_add_f32_dpp v252, v225, v224 row_ror:8 row_mask:0xf bank_mask:0x3
  v_add_f32_dpp v252, v226, v227 row_ror:8 row_mask:0xf bank_mask:0xc
  v_add_f32_dpp v253, v229, v228 row_ror:8 row_mask:0xf bank_mask:0x3
  v_add_f32_dpp v253, v230, v231 row_ror:8 row_mask:0xf bank_mask:0xc
  v_add_f32_dpp v254, v233, v232 row_ror:8 row_mask:0xf bank_mask:0x3
  v_add_f32_dpp v254, v234, v235 row_ror:8 row_mask:0xf bank_mask:0xc
  v_add_f32_dpp v255, v237, v236 row_ror:8 row_mask:0xf bank_mask:0x3
  v_add_f32_dpp v255, v238, v239 row_ror:8 row_mask:0xf bank_mask:0xc
  ds_write_b128 v28, v[252:255] offset:6144
  v_max3_f32 v11, v252, v253, v24
  v_max3_f32 v24, v254, v255, v11
  v_mul_f32 v11, s52, v24
  v_sub_f32 v10, v8, v11
  v_exp_f32 v10, v10
  v_mov_b32 v8, v11
  v_fma_f32 v240, v252, s52, -v11
  v_fma_f32 v241, v253, s52, -v11
  v_fma_f32 v242, v254, s52, -v11
  v_fma_f32 v243, v255, s52, -v11
  v_exp_f32 v240, v240
  v_exp_f32 v241, v241
  v_exp_f32 v242, v242
  v_exp_f32 v243, v243
  v_fma_f32 v9, v9, v10, v240
  v_add_f32 v11, v241, v242
  v_add_f32 v9, v9, v243
  v_add_f32 v9, v9, v11
  s_cmp_ge_u32 s3, 2
  s_cbranch_scc1 L_ni6_4
  s_waitcnt vmcnt(8)
  buffer_load_dwordx4 v[128:131], v1, s[8:11], s54 offen offset:0 nt
  buffer_load_dwordx4 v[132:135], v1, s[8:11], s54 offen offset:128 nt
  buffer_load_dwordx4 v[136:139], v1, s[8:11], s54 offen offset:256 nt
  buffer_load_dwordx4 v[140:143], v1, s[8:11], s54 offen offset:384 nt
  buffer_load_dwordx4 v[144:147], v1, s[8:11], s54 offen offset:512 nt
  buffer_load_dwordx4 v[148:151], v1, s[8:11], s54 offen offset:640 nt
  buffer_load_dwordx4 v[152:155], v1, s[8:11], s54 offen offset:768 nt
  buffer_load_dwordx4 v[156:159], v1, s[8:11], s54 offen offset:896 nt
  s_add_u32 s54, s54, 0x4000
  s_bitcmp1_b32 s54, 19
  s_cselect_b32 s55, 0x880000, 0
  s_xor_b32 s54, s54, s55
L_ni6_4:
  s_cmp_lt_u32 s3, 2
  s_cbranch_scc1 L_pw6_5
  s_waitcnt vmcnt(0)
L_pw6_5:
  ds_read_b128 v[192:195], v28 offset:24576
  ds_read_b128 v[200:203], v28 offset:26624
  ds_read_b128 v[208:211], v28 offset:28672
  ds_read_b128 v[216:219], v28 offset:30720
  ds_read_b128 v[196:199], v28 offset:25600
  ds_read_b128 v[204:207], v28 offset:27648
  ds_read_b128 v[212:215], v28 offset:29696
  ds_read_b128 v[220:223], v28 offset:31744
  v_mfma_f32_16x16x32_bf16 v[224:227], v[32:35], v[16:19], 0
  v_mfma_f32_16x16x32_bf16 v[228:231], v[40:43], v[16:19], 0
  v_mfma_f32_16x16x32_bf16 v[232:235], v[48:51], v[16:19], 0
  v_mfma_f32_16x16x32_bf16 v[236:239], v[56:59], v[16:19], 0
  v_mfma_f32_16x16x32_bf16 v[224:227], v[36:39], v[20:23], v[224:227]
  v_mfma_f32_16x16x32_bf16 v[228:231], v[44:47], v[20:23], v[228:231]
  v_mfma_f32_16x16x32_bf16 v[232:235], v[52:55], v[20:23], v[232:235]
  v_mfma_f32_16x16x32_bf16 v[236:239], v[60:63], v[20:23], v[236:239]
  s_nop 4
  v_add_f32_dpp v252, v225, v224 row_ror:8 row_mask:0xf bank_mask:0x3
  v_add_f32_dpp v252, v226, v227 row_ror:8 row_mask:0xf bank_mask:0xc
  v_add_f32_dpp v253, v229, v228 row_ror:8 row_mask:0xf bank_mask:0x3
  v_add_f32_dpp v253, v230, v231 row_ror:8 row_mask:0xf bank_mask:0xc
  v_add_f32_dpp v254, v233, v232 row_ror:8 row_mask:0xf bank_mask:0x3
  v_add_f32_dpp v254, v234, v235 row_ror:8 row_mask:0xf bank_mask:0xc
  v_add_f32_dpp v255, v237, v236 row_ror:8 row_mask:0xf bank_mask:0x3
  v_add_f32_dpp v255, v238, v239 row_ror:8 row_mask:0xf bank_mask:0xc
  ds_write_b128 v28, v[252:255] offset:4096
  v_max3_f32 v11, v252, v253, v24
  v_max3_f32 v24, v254, v255, v11
  v_mul_f32 v11, s52, v24
  v_sub_f32 v10, v8, v11
  v_exp_f32 v10, v10
  v_mov_b32 v8, v11
  v_fma_f32 v240, v252, s52, -v11
  v_fma_f32 v241, v253, s52, -v11
  v_fma_f32 v242, v254, s52, -v11
  v_fma_f32 v243, v255, s52, -v11
  v_exp_f32 v240, v240
  v_exp_f32 v241, v241
  v_exp_f32 v242, v242
  v_exp_f32 v243, v243
  v_fma_f32 v9, v9, v10, v240
  v_add_f32 v11, v241, v242
  v_add_f32 v9, v9, v243
  v_add_f32 v9, v9, v11
  s_waitcnt lgkmcnt(0)
  v_mfma_f32_16x16x32_bf16 v[224:227], v[192:195], v[16:19], 0
  v_mfma_f32_16x16x32_bf16 v[228:231], v[200:203], v[16:19], 0
  v_mfma_f32_16x16x32_bf16 v[232:235], v[208:211], v[16:19], 0
  v_mfma_f32_16x16x32_bf16 v[236:239], v[216:219], v[16:19], 0
  v_mfma_f32_16x16x32_bf16 v[224:227], v[196:199], v[20:23], v[224:227]
  v_mfma_f32_16x16x32_bf16 v[228:231], v[204:207], v[20:23], v[228:231]
  v_mfma_f32_16x16x32_bf16 v[232:235], v[212:215], v[20:23], v[232:235]
  v_mfma_f32_16x16x32_bf16 v[236:239], v[220:223], v[20:23], v[236:239]
  s_nop 4
  v_add_f32_dpp v252, v225, v224 row_ror:8 row_mask:0xf bank_mask:0x3
  v_add_f32_dpp v252, v226, v227 row_ror:8 row_mask:0xf bank_mask:0xc
  v_add_f32_dpp v253, v229, v228 row_ror:8 row_mask:0xf bank_mask:0x3
  v_add_f32_dpp v253, v230, v231 row_ror:8 row_mask:0xf bank_mask:0xc
  v_add_f32_dpp v254, v233, v232 row_ror:8 row_mask:0xf bank_mask:0x3
  v_add_f32_dpp v254, v234, v235 row_ror:8 row_mask:0xf bank_mask:0xc
  v_add_f32_dpp v255, v237, v236 row_ror:8 row_mask:0xf bank_mask:0x3
  v_add_f32_dpp v255, v238, v239 row_ror:8 row_mask:0xf bank_mask:0xc
  ds_write_b128 v28, v[252:255] offset:7168
  v_max3_f32 v11, v252, v253, v24
  v_max3_f32 v24, v254, v255, v11
  v_mul_f32 v11, s52, v24
  v_sub_f32 v10, v8, v11
  v_exp_f32 v10, v10
  v_mov_b32 v8, v11
  v_fma_f32 v240, v252, s52, -v11
  v_fma_f32 v241, v253, s52, -v11
  v_fma_f32 v242, v254, s52, -v11
  v_fma_f32 v243, v255, s52, -v11
  v_exp_f32 v240, v240
  v_exp_f32 v241, v241
  v_exp_f32 v242, v242
  v_exp_f32 v243, v243
  v_fma_f32 v9, v9, v10, v240
  v_add_f32 v11, v241, v242
  v_add_f32 v9, v9, v243
  v_add_f32 v9, v9, v11
  s_cmp_ge_u32 s3, 2
  s_cbranch_scc1 L_ni6_6
  s_waitcnt vmcnt(8)
  buffer_load_dwordx4 v[160:163], v1, s[8:11], s54 offen offset:0 nt
  buffer_load_dwordx4 v[164:167], v1, s[8:11], s54 offen offset:128 nt
  buffer_load_dwordx4 v[168:171], v1, s[8:11], s54 offen offset:256 nt
  buffer_load_dwordx4 v[172:175], v1, s[8:11], s54 offen offset:384 nt
  buffer_load_dwordx4 v[176:179], v1, s[8:11], s54 offen offset:512 nt
  buffer_load_dwordx4 v[180:183], v1, s[8:11], s54 offen offset:640 nt
  buffer_load_dwordx4 v[184:187], v1, s[8:11], s54 offen offset:768 nt
  buffer_load_dwordx4 v[188:191], v1, s[8:11], s54 offen offset:896 nt
  s_add_u32 s54, s54, 0x4000
  s_bitcmp1_b32 s54, 19
  s_cselect_b32 s55, 0x880000, 0
  s_xor_b32 s54, s54, s55
L_ni6_6:
  s_mov_b32 s53, 268
  s_branch L_pdn
L_path4:
  s_barrier
  s_add_u32 s12, s36, s55
  s_addc_u32 s13, s37, 0
  s_mov_b32 s14, 0x880000
  s_mov_b32 s15, 0x00020000
  s_setprio 2
  s_cmp_ge_u32 s3, 2
  s_cbranch_scc1 L_pr4
  s_setprio 3
L_pr4:
  s_mov_b32 s50, 0x05040100
  s_mov_b32 s51, 0x07060302
  s_mov_b32 s60, 0xff00ff00
  s_mov_b32 s61, 0xff00ff00
  s_mov_b32 s7, 2
  s_mov_b32 s6, -32
  s_mov_b32 s27, 0
  s_mov_b32 s52, 0x3e0293ee
  v_lshlrev_b32 v192, 11, v15
  v_lshl_add_u32 v2, v14, 4, v192
  v_lshrrev_b32 v195, 3, v0
  v_and_b32 v193, 3, v14
  v_mul_u32_u24 v192, 1040, v193
  v_bfe_u32 v194, v14, 2, 1
  v_lshl_add_u32 v192, v194, 9, v192
  v_lshl_add_u32 v192, v195, 5, v192
  v_add_u32 v3, 140320, v192
  v_mul_u32_u24 v192, 544, v193
  v_lshl_add_u32 v192, v194, 8, v192
  v_lshl_add_u32 v192, v195, 5, v192
  s_mul_i32 s55, s3, 2176
  s_add_u32 s58, s55, 131616
  v_add_u32 v6, s58, v192
  v_lshlrev_b32 v192, 4, v0
  v_add_u32 v28, s57, v192
  v_add_u32 v4, 8192, v28
  v_and_b32 v194, 7, v14
  v_lshl_add_u32 v7, v194, 5, v13
  s_lshl_b32 s55, s3, 3
  v_add_u32 v5, s55, v7
  v_mov_b32 v25, 131072
  s_lshl_b32 s55, s3, 2
  v_add_u32 v29, s55, v13
  v_mov_b32 v8, 0xf149f2ca
  v_mov_b32 v9, 0
  v_mov_b32 v24, 0xf149f2ca
  s_barrier
  buffer_load_dwordx4 v[32:35], v1, s[8:11], s54 offen offset:0 nt
  buffer_load_dwordx4 v[36:39], v1, s[8:11], s54 offen offset:128 nt
  buffer_load_dwordx4 v[40:43], v1, s[8:11], s54 offen offset:256 nt
  buffer_load_dwordx4 v[44:47], v1, s[8:11], s54 offen offset:384 nt
  buffer_load_dwordx4 v[48:51], v1, s[8:11], s54 offen offset:512 nt
  buffer_load_dwordx4 v[52:55], v1, s[8:11], s54 offen offset:640 nt
  buffer_load_dwordx4 v[56:59], v1, s[8:11], s54 offen offset:768 nt
  buffer_load_dwordx4 v[60:63], v1, s[8:11], s54 offen offset:896 nt
  s_add_u32 s54, s54, 0x8000
  buffer_load_dwordx4 v1, s[8:11], s54 offen offset:0 nt lds
  s_add_u32 m0, m0, 896
  s_nop 0
  buffer_load_dwordx4 v1, s[8:11], s54 offen offset:128 nt lds
  s_add_u32 m0, m0, 896
  s_nop 0
  buffer_load_dwordx4 v1, s[8:11], s54 offen offset:256 nt lds
  s_add_u32 m0, m0, 896
  s_nop 0
  buffer_load_dwordx4 v1, s[8:11], s54 offen offset:384 nt lds
  s_add_u32 m0, m0, 896
  s_nop 0
  buffer_load_dwordx4 v1, s[8:11], s54 offen offset:512 nt lds
  s_add_u32 m0, m0, 896
  s_nop 0
  buffer_load_dwordx4 v1, s[8:11], s54 offen offset:640 nt lds
  s_add_u32 m0, m0, 896
  s_nop 0
  buffer_load_dwordx4 v1, s[8:11], s54 offen offset:768 nt lds
  s_add_u32 m0, m0, 896
  s_nop 0
  buffer_load_dwordx4 v1, s[8:11], s54 offen offset:896 nt lds
  s_add_u32 m0, m0, 1920
  s_add_u32 s54, s54, 0x8000
L_wq4:
  ds_read_b32 v11, v13 offset:512
  s_waitcnt lgkmcnt(0)
  v_readfirstlane_b32 s55, v11
  s_cmp_ge_u32 s55, 4
  s_cbranch_scc1 L_wq4_d
  s_sleep 1
  s_branch L_wq4
L_wq4_d:
  ds_read_b128 v[192:195], v3 offset:0
  ds_read_b128 v[196:199], v3 offset:16
  ds_read_b128 v[200:203], v3 offset:8320
  ds_read_b128 v[204:207], v3 offset:8336
  ds_read_b128 v[208:211], v3 offset:256
  ds_read_b128 v[212:215], v3 offset:272
  ds_read_b128 v[216:219], v3 offset:8576
  ds_read_b128 v[220:223], v3 offset:8592
  s_waitcnt lgkmcnt(4)
  v_pk_add_f32 v[192:193], v[192:193], v[200:201]
  v_pk_add_f32 v[194:195], v[194:195], v[202:203]
  v_pk_add_f32 v[196:197], v[196:197], v[204:205]
  v_pk_add_f32 v[198:199], v[198:199], v[206:207]
  v_cvt_pk_bf16_f32 v16, v192, v193
  v_cvt_pk_bf16_f32 v17, v194, v195
  v_cvt_pk_bf16_f32 v18, v196, v197
  v_cvt_pk_bf16_f32 v19, v198, v199
  s_waitcnt lgkmcnt(0)
  v_pk_add_f32 v[208:209], v[208:209], v[216:217]
  v_pk_add_f32 v[210:211], v[210:211], v[218:219]
  v_pk_add_f32 v[212:213], v[212:213], v[220:221]
  v_pk_add_f32 v[214:215], v[214:215], v[222:223]
  v_cvt_pk_bf16_f32 v20, v208, v209
  v_cvt_pk_bf16_f32 v21, v210, v211
  v_cvt_pk_bf16_f32 v22, v212, v213
  v_cvt_pk_bf16_f32 v23, v214, v215
  s_waitcnt vmcnt(24)
  v_mfma_f32_16x16x32_bf16 v[224:227], v[128:131], v[16:19], 0
  v_mfma_f32_16x16x32_bf16 v[228:231], v[136:139], v[16:19], 0
  v_mfma_f32_16x16x32_bf16 v[232:235], v[144:147], v[16:19], 0
  v_mfma_f32_16x16x32_bf16 v[236:239], v[152:155], v[16:19], 0
  v_mfma_f32_16x16x32_bf16 v[224:227], v[132:135], v[20:23], v[224:227]
  v_mfma_f32_16x16x32_bf16 v[228:231], v[140:143], v[20:23], v[228:231]
  v_mfma_f32_16x16x32_bf16 v[232:235], v[148:151], v[20:23], v[232:235]
  v_mfma_f32_16x16x32_bf16 v[236:239], v[156:159], v[20:23], v[236:239]
  buffer_load_dwordx4 v[128:131], v1, s[8:11], s54 offen offset:0 nt
  buffer_load_dwordx4 v[132:135], v1, s[8:11], s54 offen offset:128 nt
  buffer_load_dwordx4 v[136:139], v1, s[8:11], s54 offen offset:256 nt
  buffer_load_dwordx4 v[140:143], v1, s[8:11], s54 offen offset:384 nt
  buffer_load_dwordx4 v[144:147], v1, s[8:11], s54 offen offset:512 nt
  buffer_load_dwordx4 v[148:151], v1, s[8:11], s54 offen offset:640 nt
  buffer_load_dwordx4 v[152:155], v1, s[8:11], s54 offen offset:768 nt
  buffer_load_dwordx4 v[156:159], v1, s[8:11], s54 offen offset:896 nt
  s_add_u32 s54, s54, 0x8000
  s_nop 2
  v_add_f32_dpp v252, v225, v224 row_ror:8 row_mask:0xf bank_mask:0x3
  v_add_f32_dpp v252, v226, v227 row_ror:8 row_mask:0xf bank_mask:0xc
  v_add_f32_dpp v253, v229, v228 row_ror:8 row_mask:0xf bank_mask:0x3
  v_add_f32_dpp v253, v230, v231 row_ror:8 row_mask:0xf bank_mask:0xc
  v_add_f32_dpp v254, v233, v232 row_ror:8 row_mask:0xf bank_mask:0x3
  v_add_f32_dpp v254, v234, v235 row_ror:8 row_mask:0xf bank_mask:0xc
  v_add_f32_dpp v255, v237, v236 row_ror:8 row_mask:0xf bank_mask:0x3
  v_add_f32_dpp v255, v238, v239 row_ror:8 row_mask:0xf bank_mask:0xc
  ds_write_b128 v28, v[252:255] offset:2048
  v_max3_f32 v11, v252, v253, v24
  v_max3_f32 v24, v254, v255, v11
  v_mul_f32 v11, s52, v24
  v_sub_f32 v10, v8, v11
  v_exp_f32 v10, v10
  v_mov_b32 v8, v11
  v_fma_f32 v240, v252, s52, -v11
  v_fma_f32 v241, v253, s52, -v11
  v_fma_f32 v242, v254, s52, -v11
  v_fma_f32 v243, v255, s52, -v11
  v_exp_f32 v240, v240
  v_exp_f32 v241, v241
  v_exp_f32 v242, v242
  v_exp_f32 v243, v243
  v_fma_f32 v9, v9, v10, v240
  v_add_f32 v11, v241, v242
  v_add_f32 v9, v9, v243
  v_add_f32 v9, v9, v11
  v_mfma_f32_16x16x32_bf16 v[224:227], v[64:67], v[16:19], 0
  v_mfma_f32_16x16x32_bf16 v[228:231], v[72:75], v[16:19], 0
  v_mfma_f32_16x16x32_bf16 v[232:235], v[80:83], v[16:19], 0
  v_mfma_f32_16x16x32_bf16 v[236:239], v[88:91], v[16:19], 0
  v_mfma_f32_16x16x32_bf16 v[224:227], v[68:71], v[20:23], v[224:227]
  v_mfma_f32_16x16x32_bf16 v[228:231], v[76:79], v[20:23], v[228:231]
  v_mfma_f32_16x16x32_bf16 v[232:235], v[84:87], v[20:23], v[232:235]
  v_mfma_f32_16x16x32_bf16 v[236:239], v[92:95], v[20:23], v[236:239]
  s_nop 4
  v_add_f32_dpp v252, v225, v224 row_ror:8 row_mask:0xf bank_mask:0x3
  v_add_f32_dpp v252, v226, v227 row_ror:8 row_mask:0xf bank_mask:0xc
  v_add_f32_dpp v253, v229, v228 row_ror:8 row_mask:0xf bank_mask:0x3
  v_add_f32_dpp v253, v230, v231 row_ror:8 row_mask:0xf bank_mask:0xc
  v_add_f32_dpp v254, v233, v232 row_ror:8 row_mask:0xf bank_mask:0x3
  v_add_f32_dpp v254, v234, v235 row_ror:8 row_mask:0xf bank_mask:0xc
  v_add_f32_dpp v255, v237, v236 row_ror:8 row_mask:0xf bank_mask:0x3
  v_add_f32_dpp v255, v238, v239 row_ror:8 row_mask:0xf bank_mask:0xc
  ds_write_b128 v28, v[252:255] offset:0
  v_max3_f32 v11, v252, v253, v24
  v_max3_f32 v24, v254, v255, v11
  v_mul_f32 v11, s52, v24
  v_sub_f32 v10, v8, v11
  v_exp_f32 v10, v10
  v_mov_b32 v8, v11
  v_fma_f32 v240, v252, s52, -v11
  v_fma_f32 v241, v253, s52, -v11
  v_fma_f32 v242, v254, s52, -v11
  v_fma_f32 v243, v255, s52, -v11
  v_exp_f32 v240, v240
  v_exp_f32 v241, v241
  v_exp_f32 v242, v242
  v_exp_f32 v243, v243
  v_fma_f32 v9, v9, v10, v240
  v_add_f32 v11, v241, v242
  v_add_f32 v9, v9, v243
  v_add_f32 v9, v9, v11
  s_waitcnt vmcnt(24)
  v_mfma_f32_16x16x32_bf16 v[224:227], v[160:163], v[16:19], 0
  v_mfma_f32_16x16x32_bf16 v[228:231], v[168:171], v[16:19], 0
  v_mfma_f32_16x16x32_bf16 v[232:235], v[176:179], v[16:19], 0
  v_mfma_f32_16x16x32_bf16 v[236:239], v[184:187], v[16:19], 0
  v_mfma_f32_16x16x32_bf16 v[224:227], v[164:167], v[20:23], v[224:227]
  v_mfma_f32_16x16x32_bf16 v[228:231], v[172:175], v[20:23], v[228:231]
  v_mfma_f32_16x16x32_bf16 v[232:235], v[180:183], v[20:23], v[232:235]
  v_mfma_f32_16x16x32_bf16 v[236:239], v[188:191], v[20:23], v[236:239]
  buffer_load_dwordx4 v[160:163], v1, s[8:11], s54 offen offset:0 nt
  buffer_load_dwordx4 v[164:167], v1, s[8:11], s54 offen offset:128 nt
  buffer_load_dwordx4 v[168:171], v1, s[8:11], s54 offen offset:256 nt
  buffer_load_dwordx4 v[172:175], v1, s[8:11], s54 offen offset:384 nt
  buffer_load_dwordx4 v[176:179], v1, s[8:11], s54 offen offset:512 nt
  buffer_load_dwordx4 v[180:183], v1, s[8:11], s54 offen offset:640 nt
  buffer_load_dwordx4 v[184:187], v1, s[8:11], s54 offen offset:768 nt
  buffer_load_dwordx4 v[188:191], v1, s[8:11], s54 offen offset:896 nt
  s_add_u32 s54, s54, 0x8000
  s_nop 2
  v_add_f32_dpp v252, v225, v224 row_ror:8 row_mask:0xf bank_mask:0x3
  v_add_f32_dpp v252, v226, v227 row_ror:8 row_mask:0xf bank_mask:0xc
  v_add_f32_dpp v253, v229, v228 row_ror:8 row_mask:0xf bank_mask:0x3
  v_add_f32_dpp v253, v230, v231 row_ror:8 row_mask:0xf bank_mask:0xc
  v_add_f32_dpp v254, v233, v232 row_ror:8 row_mask:0xf bank_mask:0x3
  v_add_f32_dpp v254, v234, v235 row_ror:8 row_mask:0xf bank_mask:0xc
  v_add_f32_dpp v255, v237, v236 row_ror:8 row_mask:0xf bank_mask:0x3
  v_add_f32_dpp v255, v238, v239 row_ror:8 row_mask:0xf bank_mask:0xc
  ds_write_b128 v28, v[252:255] offset:3072
  v_max3_f32 v11, v252, v253, v24
  v_max3_f32 v24, v254, v255, v11
  v_mul_f32 v11, s52, v24
  v_sub_f32 v10, v8, v11
  v_exp_f32 v10, v10
  v_mov_b32 v8, v11
  v_fma_f32 v240, v252, s52, -v11
  v_fma_f32 v241, v253, s52, -v11
  v_fma_f32 v242, v254, s52, -v11
  v_fma_f32 v243, v255, s52, -v11
  v_exp_f32 v240, v240
  v_exp_f32 v241, v241
  v_exp_f32 v242, v242
  v_exp_f32 v243, v243
  v_fma_f32 v9, v9, v10, v240
  v_add_f32 v11, v241, v242
  v_add_f32 v9, v9, v243
  v_add_f32 v9, v9, v11
  v_mfma_f32_16x16x32_bf16 v[224:227], v[96:99], v[16:19], 0
  v_mfma_f32_16x16x32_bf16 v[228:231], v[104:107], v[16:19], 0
  v_mfma_f32_16x16x32_bf16 v[232:235], v[112:115], v[16:19], 0
  v_mfma_f32_16x16x32_bf16 v[236:239], v[120:123], v[16:19], 0
  v_mfma_f32_16x16x32_bf16 v[224:227], v[100:103], v[20:23], v[224:227]
  v_mfma_f32_16x16x32_bf16 v[228:231], v[108:111], v[20:23], v[228:231]
  v_mfma_f32_16x16x32_bf16 v[232:235], v[116:119], v[20:23], v[232:235]
  v_mfma_f32_16x16x32_bf16 v[236:239], v[124:127], v[20:23], v[236:239]
  s_nop 4
  v_add_f32_dpp v252, v225, v224 row_ror:8 row_mask:0xf bank_mask:0x3
  v_add_f32_dpp v252, v226, v227 row_ror:8 row_mask:0xf bank_mask:0xc
  v_add_f32_dpp v253, v229, v228 row_ror:8 row_mask:0xf bank_mask:0x3
  v_add_f32_dpp v253, v230, v231 row_ror:8 row_mask:0xf bank_mask:0xc
  v_add_f32_dpp v254, v233, v232 row_ror:8 row_mask:0xf bank_mask:0x3
  v_add_f32_dpp v254, v234, v235 row_ror:8 row_mask:0xf bank_mask:0xc
  v_add_f32_dpp v255, v237, v236 row_ror:8 row_mask:0xf bank_mask:0x3
  v_add_f32_dpp v255, v238, v239 row_ror:8 row_mask:0xf bank_mask:0xc
  ds_write_b128 v28, v[252:255] offset:1024
  v_max3_f32 v11, v252, v253, v24
  v_max3_f32 v24, v254, v255, v11
  v_mul_f32 v11, s52, v24
  v_sub_f32 v10, v8, v11
  v_exp_f32 v10, v10
  v_mov_b32 v8, v11
  v_fma_f32 v240, v252, s52, -v11
  v_fma_f32 v241, v253, s52, -v11
  v_fma_f32 v242, v254, s52, -v11
  v_fma_f32 v243, v255, s52, -v11
  v_exp_f32 v240, v240
  v_exp_f32 v241, v241
  v_exp_f32 v242, v242
  v_exp_f32 v243, v243
  v_fma_f32 v9, v9, v10, v240
  v_add_f32 v11, v241, v242
  v_add_f32 v9, v9, v243
  v_add_f32 v9, v9, v11
  s_waitcnt vmcnt(24)
  v_mfma_f32_16x16x32_bf16 v[224:227], v[32:35], v[16:19], 0
  v_mfma_f32_16x16x32_bf16 v[228:231], v[40:43], v[16:19], 0
  v_mfma_f32_16x16x32_bf16 v[232:235], v[48:51], v[16:19], 0
  v_mfma_f32_16x16x32_bf16 v[236:239], v[56:59], v[16:19], 0
  v_mfma_f32_16x16x32_bf16 v[224:227], v[36:39], v[20:23], v[224:227]
  v_mfma_f32_16x16x32_bf16 v[228:231], v[44:47], v[20:23], v[228:231]
  v_mfma_f32_16x16x32_bf16 v[232:235], v[52:55], v[20:23], v[232:235]
  v_mfma_f32_16x16x32_bf16 v[236:239], v[60:63], v[20:23], v[236:239]
  s_nop 4
  v_add_f32_dpp v252, v225, v224 row_ror:8 row_mask:0xf bank_mask:0x3
  v_add_f32_dpp v252, v226, v227 row_ror:8 row_mask:0xf bank_mask:0xc
  v_add_f32_dpp v253, v229, v228 row_ror:8 row_mask:0xf bank_mask:0x3
  v_add_f32_dpp v253, v230, v231 row_ror:8 row_mask:0xf bank_mask:0xc
  v_add_f32_dpp v254, v233, v232 row_ror:8 row_mask:0xf bank_mask:0x3
  v_add_f32_dpp v254, v234, v235 row_ror:8 row_mask:0xf bank_mask:0xc
  v_add_f32_dpp v255, v237, v236 row_ror:8 row_mask:0xf bank_mask:0x3
  v_add_f32_dpp v255, v238, v239 row_ror:8 row_mask:0xf bank_mask:0xc
  ds_write_b128 v28, v[252:255] offset:4096
  v_max3_f32 v11, v252, v253, v24
  v_max3_f32 v24, v254, v255, v11
  v_mul_f32 v11, s52, v24
  v_sub_f32 v10, v8, v11
  v_exp_f32 v10, v10
  v_mov_b32 v8, v11
  v_fma_f32 v240, v252, s52, -v11
  v_fma_f32 v241, v253, s52, -v11
  v_fma_f32 v242, v254, s52, -v11
  v_fma_f32 v243, v255, s52, -v11
  v_exp_f32 v240, v240
  v_exp_f32 v241, v241
  v_exp_f32 v242, v242
  v_exp_f32 v243, v243
  v_fma_f32 v9, v9, v10, v240
  v_add_f32 v11, v241, v242
  v_add_f32 v9, v9, v243
  v_add_f32 v9, v9, v11
  s_waitcnt vmcnt(16)
  ds_read_b128 v[192:195], v28 offset:8192
  ds_read_b128 v[200:203], v28 offset:10240
  ds_read_b128 v[208:211], v28 offset:12288
  ds_read_b128 v[216:219], v28 offset:14336
  ds_read_b128 v[196:199], v28 offset:9216
  ds_read_b128 v[204:207], v28 offset:11264
  ds_read_b128 v[212:215], v28 offset:13312
  ds_read_b128 v[220:223], v28 offset:15360
  s_cmp_ge_u32 s3, 2
  s_cbranch_scc1 L_ni4_1
  buffer_load_dwordx4 v[64:67], v1, s[8:11], s54 offen offset:0 nt
  buffer_load_dwordx4 v[68:71], v1, s[8:11], s54 offen offset:128 nt
  buffer_load_dwordx4 v[72:75], v1, s[8:11], s54 offen offset:256 nt
  buffer_load_dwordx4 v[76:79], v1, s[8:11], s54 offen offset:384 nt
  buffer_load_dwordx4 v[80:83], v1, s[8:11], s54 offen offset:512 nt
  buffer_load_dwordx4 v[84:87], v1, s[8:11], s54 offen offset:640 nt
  buffer_load_dwordx4 v[88:91], v1, s[8:11], s54 offen offset:768 nt
  buffer_load_dwordx4 v[92:95], v1, s[8:11], s54 offen offset:896 nt
  s_add_u32 s54, s54, 0x4000
  s_bitcmp1_b32 s54, 19
  s_cselect_b32 s55, 0x880000, 0
  s_xor_b32 s54, s54, s55
L_ni4_1:
  s_waitcnt lgkmcnt(0)
  v_mfma_f32_16x16x32_bf16 v[224:227], v[192:195], v[16:19], 0
  v_mfma_f32_16x16x32_bf16 v[228:231], v[200:203], v[16:19], 0
  v_mfma_f32_16x16x32_bf16 v[232:235], v[208:211], v[16:19], 0
  v_mfma_f32_16x16x32_bf16 v[236:239], v[216:219], v[16:19], 0
  v_mfma_f32_16x16x32_bf16 v[224:227], v[196:199], v[20:23], v[224:227]
  v_mfma_f32_16x16x32_bf16 v[228:231], v[204:207], v[20:23], v[228:231]
  v_mfma_f32_16x16x32_bf16 v[232:235], v[212:215], v[20:23], v[232:235]
  v_mfma_f32_16x16x32_bf16 v[236:239], v[220:223], v[20:23], v[236:239]
  s_nop 4
  v_add_f32_dpp v252, v225, v224 row_ror:8 row_mask:0xf bank_mask:0x3
  v_add_f32_dpp v252, v226, v227 row_ror:8 row_mask:0xf bank_mask:0xc
  v_add_f32_dpp v253, v229, v228 row_ror:8 row_mask:0xf bank_mask:0x3
  v_add_f32_dpp v253, v230, v231 row_ror:8 row_mask:0xf bank_mask:0xc
  v_add_f32_dpp v254, v233, v232 row_ror:8 row_mask:0xf bank_mask:0x3
  v_add_f32_dpp v254, v234, v235 row_ror:8 row_mask:0xf bank_mask:0xc
  v_add_f32_dpp v255, v237, v236 row_ror:8 row_mask:0xf bank_mask:0x3
  v_add_f32_dpp v255, v238, v239 row_ror:8 row_mask:0xf bank_mask:0xc
  ds_write_b128 v28, v[252:255] offset:5120
  v_max3_f32 v11, v252, v253, v24
  v_max3_f32 v24, v254, v255, v11
  v_mul_f32 v11, s52, v24
  v_sub_f32 v10, v8, v11
  v_exp_f32 v10, v10
  v_mov_b32 v8, v11
  v_fma_f32 v240, v252, s52, -v11
  v_fma_f32 v241, v253, s52, -v11
  v_fma_f32 v242, v254, s52, -v11
  v_fma_f32 v243, v255, s52, -v11
  v_exp_f32 v240, v240
  v_exp_f32 v241, v241
  v_exp_f32 v242, v242
  v_exp_f32 v243, v243
  v_fma_f32 v9, v9, v10, v240
  v_add_f32 v11, v241, v242
  v_add_f32 v9, v9, v243
  v_add_f32 v9, v9, v11
  s_cmp_lt_u32 s3, 2
  s_cbranch_scc1 L_pw4_2
  s_waitcnt vmcnt(8)
L_pw4_2:
  s_waitcnt vmcnt(16)
  s_cmp_ge_u32 s3, 2
  s_cbranch_scc1 L_ni4_3
  buffer_load_dwordx4 v[96:99], v1, s[8:11], s54 offen offset:0 nt
  buffer_load_dwordx4 v[100:103], v1, s[8:11], s54 offen offset:128 nt
  buffer_load_dwordx4 v[104:107], v1, s[8:11], s54 offen offset:256 nt
  buffer_load_dwordx4 v[108:111], v1, s[8:11], s54 offen offset:384 nt
  buffer_load_dwordx4 v[112:115], v1, s[8:11], s54 offen offset:512 nt
  buffer_load_dwordx4 v[116:119], v1, s[8:11], s54 offen offset:640 nt
  buffer_load_dwordx4 v[120:123], v1, s[8:11], s54 offen offset:768 nt
  buffer_load_dwordx4 v[124:127], v1, s[8:11], s54 offen offset:896 nt
  s_add_u32 s54, s54, 0x4000
  s_bitcmp1_b32 s54, 19
  s_cselect_b32 s55, 0x880000, 0
  s_xor_b32 s54, s54, s55
L_ni4_3:
  v_mfma_f32_16x16x32_bf16 v[224:227], v[128:131], v[16:19], 0
  v_mfma_f32_16x16x32_bf16 v[228:231], v[136:139], v[16:19], 0
  v_mfma_f32_16x16x32_bf16 v[232:235], v[144:147], v[16:19], 0
  v_mfma_f32_16x16x32_bf16 v[236:239], v[152:155], v[16:19], 0
  v_mfma_f32_16x16x32_bf16 v[224:227], v[132:135], v[20:23], v[224:227]
  v_mfma_f32_16x16x32_bf16 v[228:231], v[140:143], v[20:23], v[228:231]
  v_mfma_f32_16x16x32_bf16 v[232:235], v[148:151], v[20:23], v[232:235]
  v_mfma_f32_16x16x32_bf16 v[236:239], v[156:159], v[20:23], v[236:239]
  s_nop 4
  v_add_f32_dpp v252, v225, v224 row_ror:8 row_mask:0xf bank_mask:0x3
  v_add_f32_dpp v252, v226, v227 row_ror:8 row_mask:0xf bank_mask:0xc
  v_add_f32_dpp v253, v229, v228 row_ror:8 row_mask:0xf bank_mask:0x3
  v_add_f32_dpp v253, v230, v231 row_ror:8 row_mask:0xf bank_mask:0xc
  v_add_f32_dpp v254, v233, v232 row_ror:8 row_mask:0xf bank_mask:0x3
  v_add_f32_dpp v254, v234, v235 row_ror:8 row_mask:0xf bank_mask:0xc
  v_add_f32_dpp v255, v237, v236 row_ror:8 row_mask:0xf bank_mask:0x3
  v_add_f32_dpp v255, v238, v239 row_ror:8 row_mask:0xf bank_mask:0xc
  ds_write_b128 v28, v[252:255] offset:6144
  v_max3_f32 v11, v252, v253, v24
  v_max3_f32 v24, v254, v255, v11
  v_mul_f32 v11, s52, v24
  v_sub_f32 v10, v8, v11
  v_exp_f32 v10, v10
  v_mov_b32 v8, v11
  v_fma_f32 v240, v252, s52, -v11
  v_fma_f32 v241, v253, s52, -v11
  v_fma_f32 v242, v254, s52, -v11
  v_fma_f32 v243, v255, s52, -v11
  v_exp_f32 v240, v240
  v_exp_f32 v241, v241
  v_exp_f32 v242, v242
  v_exp_f32 v243, v243
  v_fma_f32 v9, v9, v10, v240
  v_add_f32 v11, v241, v242
  v_add_f32 v9, v9, v243
  v_add_f32 v9, v9, v11
  s_cmp_lt_u32 s3, 2
  s_cbranch_scc1 L_pw4_4
  s_waitcnt vmcnt(0)
L_pw4_4:
  s_waitcnt vmcnt(16)
  v_mfma_f32_16x16x32_bf16 v[224:227], v[160:163], v[16:19], 0
  v_mfma_f32_16x16x32_bf16 v[228:231], v[168:171], v[16:19], 0
  v_mfma_f32_16x16x32_bf16 v[232:235], v[176:179], v[16:19], 0
  v_mfma_f32_16x16x32_bf16 v[236:239], v[184:187], v[16:19], 0
  v_mfma_f32_16x16x32_bf16 v[224:227], v[164:167], v[20:23], v[224:227]
  v_mfma_f32_16x16x32_bf16 v[228:231], v[172:175], v[20:23], v[228:231]
  v_mfma_f32_16x16x32_bf16 v[232:235], v[180:183], v[20:23], v[232:235]
  v_mfma_f32_16x16x32_bf16 v[236:239], v[188:191], v[20:23], v[236:239]
  s_nop 4
  v_add_f32_dpp v252, v225, v224 row_ror:8 row_mask:0xf bank_mask:0x3
  v_add_f32_dpp v252, v226, v227 row_ror:8 row_mask:0xf bank_mask:0xc
  v_add_f32_dpp v253, v229, v228 row_ror:8 row_mask:0xf bank_mask:0x3
  v_add_f32_dpp v253, v230, v231 row_ror:8 row_mask:0xf bank_mask:0xc
  v_add_f32_dpp v254, v233, v232 row_ror:8 row_mask:0xf bank_mask:0x3
  v_add_f32_dpp v254, v234, v235 row_ror:8 row_mask:0xf bank_mask:0xc
  v_add_f32_dpp v255, v237, v236 row_ror:8 row_mask:0xf bank_mask:0x3
  v_add_f32_dpp v255, v238, v239 row_ror:8 row_mask:0xf bank_mask:0xc
  ds_write_b128 v28, v[252:255] offset:7168
  v_max3_f32 v11, v252, v253, v24
  v_max3_f32 v24, v254, v255, v11
  v_mul_f32 v11, s52, v24
  v_sub_f32 v10, v8, v11
  v_exp_f32 v10, v10
  v_mov_b32 v8, v11
  v_fma_f32 v240, v252, s52, -v11
  v_fma_f32 v241, v253, s52, -v11
  v_fma_f32 v242, v254, s52, -v11
  v_fma_f32 v243, v255, s52, -v11
  v_exp_f32 v240, v240
  v_exp_f32 v241, v241
  v_exp_f32 v242, v242
  v_exp_f32 v243, v243
  v_fma_f32 v9, v9, v10, v240
  v_add_f32 v11, v241, v242
  v_add_f32 v9, v9, v243
  v_add_f32 v9, v9, v11
  s_mov_b32 s53, 12
  s_branch L_pdn
L_path2:
  s_barrier
  s_add_u32 s12, s36, s55
  s_addc_u32 s13, s37, 0
  s_mov_b32 s14, 0x880000
  s_mov_b32 s15, 0x00020000
  s_setprio 2
  s_cmp_ge_u32 s3, 2
  s_cbranch_scc1 L_pr2
  s_setprio 3
L_pr2:
  s_mov_b32 s50, 0x05040100
  s_mov_b32 s51, 0x07060302
  s_mov_b32 s60, 0xff00ff00
  s_mov_b32 s61, 0xff00ff00
  s_mov_b32 s7, 2
  s_mov_b32 s6, -32
  s_mov_b32 s27, 0
  s_mov_b32 s52, 0x3e0293ee
  v_lshlrev_b32 v192, 11, v15
  v_lshl_add_u32 v2, v14, 4, v192
  v_lshrrev_b32 v195, 3, v0
  v_and_b32 v193, 3, v14
  v_mul_u32_u24 v192, 1040, v193
  v_bfe_u32 v194, v14, 2, 1
  v_lshl_add_u32 v192, v194, 9, v192
  v_lshl_add_u32 v192, v195, 5, v192
  v_add_u32 v3, 140320, v192
  v_mul_u32_u24 v192, 544, v193
  v_lshl_add_u32 v192, v194, 8, v192
  v_lshl_add_u32 v192, v195, 5, v192
  s_mul_i32 s55, s3, 2176
  s_add_u32 s58, s55, 131616
  v_add_u32 v6, s58, v192
  v_lshlrev_b32 v192, 4, v0
  v_add_u32 v28, s57, v192
  v_add_u32 v4, 8192, v28
  v_and_b32 v194, 7, v14
  v_lshl_add_u32 v7, v194, 5, v13
  s_lshl_b32 s55, s3, 3
  v_add_u32 v5, s55, v7
  v_mov_b32 v25, 131072
  s_lshl_b32 s55, s3, 2
  v_add_u32 v29, s55, v13
  v_mov_b32 v8, 0xf149f2ca
  v_mov_b32 v9, 0
  v_mov_b32 v24, 0xf149f2ca
  s_barrier
  buffer_load_dwordx4 v[128:131], v1, s[8:11], s54 offen offset:0 nt
  buffer_load_dwordx4 v[132:135], v1, s[8:11], s54 offen offset:128 nt
  buffer_load_dwordx4 v[136:139], v1, s[8:11], s54 offen offset:256 nt
  buffer_load_dwordx4 v[140:143], v1, s[8:11], s54 offen offset:384 nt
  buffer_load_dwordx4 v[144:147], v1, s[8:11], s54 offen offset:512 nt
  buffer_load_dwordx4 v[148:151], v1, s[8:11], s54 offen offset:640 nt
  buffer_load_dwordx4 v[152:155], v1, s[8:11], s54 offen offset:768 nt
  buffer_load_dwordx4 v[156:159], v1, s[8:11], s54 offen offset:896 nt
  s_add_u32 s54, s54, 0x8000
  buffer_load_dwordx4 v[160:163], v1, s[8:11], s54 offen offset:0 nt
  buffer_load_dwordx4 v[164:167], v1, s[8:11], s54 offen offset:128 nt
  buffer_load_dwordx4 v[168:171], v1, s[8:11], s54 offen offset:256 nt
  buffer_load_dwordx4 v[172:175], v1, s[8:11], s54 offen offset:384 nt
  buffer_load_dwordx4 v[176:179], v1, s[8:11], s54 offen offset:512 nt
  buffer_load_dwordx4 v[180:183], v1, s[8:11], s54 offen offset:640 nt
  buffer_load_dwordx4 v[184:187], v1, s[8:11], s54 offen offset:768 nt
  buffer_load_dwordx4 v[188:191], v1, s[8:11], s54 offen offset:896 nt
  s_add_u32 s54, s54, 0x8000
L_wq2:
  ds_read_b32 v11, v13 offset:512
  s_waitcnt lgkmcnt(0)
  v_readfirstlane_b32 s55, v11
  s_cmp_ge_u32 s55, 4
  s_cbranch_scc1 L_wq2_d
  s_sleep 1
  s_branch L_wq2
L_wq2_d:
  ds_read_b128 v[192:195], v3 offset:0
  ds_read_b128 v[196:199], v3 offset:16
  ds_read_b128 v[200:203], v3 offset:8320
  ds_read_b128 v[204:207], v3 offset:8336
  ds_read_b128 v[208:211], v3 offset:256
  ds_read_b128 v[212:215], v3 offset:272
  ds_read_b128 v[216:219], v3 offset:8576
  ds_read_b128 v[220:223], v3 offset:8592
  s_waitcnt lgkmcnt(4)
  v_pk_add_f32 v[192:193], v[192:193], v[200:201]
  v_pk_add_f32 v[194:195], v[194:195], v[202:203]
  v_pk_add_f32 v[196:197], v[196:197], v[204:205]
  v_pk_add_f32 v[198:199], v[198:199], v[206:207]
  v_cvt_pk_bf16_f32 v16, v192, v193
  v_cvt_pk_bf16_f32 v17, v194, v195
  v_cvt_pk_bf16_f32 v18, v196, v197
  v_cvt_pk_bf16_f32 v19, v198, v199
  s_waitcnt lgkmcnt(0)
  v_pk_add_f32 v[208:209], v[208:209], v[216:217]
  v_pk_add_f32 v[210:211], v[210:211], v[218:219]
  v_pk_add_f32 v[212:213], v[212:213], v[220:221]
  v_pk_add_f32 v[214:215], v[214:215], v[222:223]
  v_cvt_pk_bf16_f32 v20, v208, v209
  v_cvt_pk_bf16_f32 v21, v210, v211
  v_cvt_pk_bf16_f32 v22, v212, v213
  v_cvt_pk_bf16_f32 v23, v214, v215
  s_waitcnt vmcnt(24)
  v_mfma_f32_16x16x32_bf16 v[224:227], v[64:67], v[16:19], 0
  v_mfma_f32_16x16x32_bf16 v[228:231], v[72:75], v[16:19], 0
  v_mfma_f32_16x16x32_bf16 v[232:235], v[80:83], v[16:19], 0
  v_mfma_f32_16x16x32_bf16 v[236:239], v[88:91], v[16:19], 0
  v_mfma_f32_16x16x32_bf16 v[224:227], v[68:71], v[20:23], v[224:227]
  v_mfma_f32_16x16x32_bf16 v[228:231], v[76:79], v[20:23], v[228:231]
  v_mfma_f32_16x16x32_bf16 v[232:235], v[84:87], v[20:23], v[232:235]
  v_mfma_f32_16x16x32_bf16 v[236:239], v[92:95], v[20:23], v[236:239]
  buffer_load_dwordx4 v[64:67], v1, s[8:11], s54 offen offset:0 nt
  buffer_load_dwordx4 v[68:71], v1, s[8:11], s54 offen offset:128 nt
  buffer_load_dwordx4 v[72:75], v1, s[8:11], s54 offen offset:256 nt
  buffer_load_dwordx4 v[76:79], v1, s[8:11], s54 offen offset:384 nt
  buffer_load_dwordx4 v[80:83], v1, s[8:11], s54 offen offset:512 nt
  buffer_load_dwordx4 v[84:87], v1, s[8:11], s54 offen offset:640 nt
  buffer_load_dwordx4 v[88:91], v1, s[8:11], s54 offen offset:768 nt
  buffer_load_dwordx4 v[92:95], v1, s[8:11], s54 offen offset:896 nt
  s_add_u32 s54, s54, 0x8000
  s_nop 2
  v_add_f32_dpp v252, v225, v224 row_ror:8 row_mask:0xf bank_mask:0x3
  v_add_f32_dpp v252, v226, v227 row_ror:8 row_mask:0xf bank_mask:0xc
  v_add_f32_dpp v253, v229, v228 row_ror:8 row_mask:0xf bank_mask:0x3
  v_add_f32_dpp v253, v230, v231 row_ror:8 row_mask:0xf bank_mask:0xc
  v_add_f32_dpp v254, v233, v232 row_ror:8 row_mask:0xf bank_mask:0x3
  v_add_f32_dpp v254, v234, v235 row_ror:8 row_mask:0xf bank_mask:0xc
  v_add_f32_dpp v255, v237, v236 row_ror:8 row_mask:0xf bank_mask:0x3
  v_add_f32_dpp v255, v238, v239 row_ror:8 row_mask:0xf bank_mask:0xc
  ds_write_b128 v28, v[252:255] offset:0
  v_max3_f32 v11, v252, v253, v24
  v_max3_f32 v24, v254, v255, v11
  v_mul_f32 v11, s52, v24
  v_sub_f32 v10, v8, v11
  v_exp_f32 v10, v10
  v_mov_b32 v8, v11
  v_fma_f32 v240, v252, s52, -v11
  v_fma_f32 v241, v253, s52, -v11
  v_fma_f32 v242, v254, s52, -v11
  v_fma_f32 v243, v255, s52, -v11
  v_exp_f32 v240, v240
  v_exp_f32 v241, v241
  v_exp_f32 v242, v242
  v_exp_f32 v243, v243
  v_fma_f32 v9, v9, v10, v240
  v_add_f32 v11, v241, v242
  v_add_f32 v9, v9, v243
  v_add_f32 v9, v9, v11
  s_waitcnt vmcnt(24)
  v_mfma_f32_16x16x32_bf16 v[224:227], v[96:99], v[16:19], 0
  v_mfma_f32_16x16x32_bf16 v[228:231], v[104:107], v[16:19], 0
  v_mfma_f32_16x16x32_bf16 v[232:235], v[112:115], v[16:19], 0
  v_mfma_f32_16x16x32_bf16 v[236:239], v[120:123], v[16:19], 0
  v_mfma_f32_16x16x32_bf16 v[224:227], v[100:103], v[20:23], v[224:227]
  v_mfma_f32_16x16x32_bf16 v[228:231], v[108:111], v[20:23], v[228:231]
  v_mfma_f32_16x16x32_bf16 v[232:235], v[116:119], v[20:23], v[232:235]
  v_mfma_f32_16x16x32_bf16 v[236:239], v[124:127], v[20:23], v[236:239]
  buffer_load_dwordx4 v[96:99], v1, s[8:11], s54 offen offset:0 nt
  buffer_load_dwordx4 v[100:103], v1, s[8:11], s54 offen offset:128 nt
  buffer_load_dwordx4 v[104:107], v1, s[8:11], s54 offen offset:256 nt
  buffer_load_dwordx4 v[108:111], v1, s[8:11], s54 offen offset:384 nt
  buffer_load_dwordx4 v[112:115], v1, s[8:11], s54 offen offset:512 nt
  buffer_load_dwordx4 v[116:119], v1, s[8:11], s54 offen offset:640 nt
  buffer_load_dwordx4 v[120:123], v1, s[8:11], s54 offen offset:768 nt
  buffer_load_dwordx4 v[124:127], v1, s[8:11], s54 offen offset:896 nt
  s_add_u32 s54, s54, 0x8000
  s_nop 2
  v_add_f32_dpp v252, v225, v224 row_ror:8 row_mask:0xf bank_mask:0x3
  v_add_f32_dpp v252, v226, v227 row_ror:8 row_mask:0xf bank_mask:0xc
  v_add_f32_dpp v253, v229, v228 row_ror:8 row_mask:0xf bank_mask:0x3
  v_add_f32_dpp v253, v230, v231 row_ror:8 row_mask:0xf bank_mask:0xc
  v_add_f32_dpp v254, v233, v232 row_ror:8 row_mask:0xf bank_mask:0x3
  v_add_f32_dpp v254, v234, v235 row_ror:8 row_mask:0xf bank_mask:0xc
  v_add_f32_dpp v255, v237, v236 row_ror:8 row_mask:0xf bank_mask:0x3
  v_add_f32_dpp v255, v238, v239 row_ror:8 row_mask:0xf bank_mask:0xc
  ds_write_b128 v28, v[252:255] offset:1024
  v_max3_f32 v11, v252, v253, v24
  v_max3_f32 v24, v254, v255, v11
  v_mul_f32 v11, s52, v24
  v_sub_f32 v10, v8, v11
  v_exp_f32 v10, v10
  v_mov_b32 v8, v11
  v_fma_f32 v240, v252, s52, -v11
  v_fma_f32 v241, v253, s52, -v11
  v_fma_f32 v242, v254, s52, -v11
  v_fma_f32 v243, v255, s52, -v11
  v_exp_f32 v240, v240
  v_exp_f32 v241, v241
  v_exp_f32 v242, v242
  v_exp_f32 v243, v243
  v_fma_f32 v9, v9, v10, v240
  v_add_f32 v11, v241, v242
  v_add_f32 v9, v9, v243
  v_add_f32 v9, v9, v11
  s_waitcnt vmcnt(24)
  v_mfma_f32_16x16x32_bf16 v[224:227], v[128:131], v[16:19], 0
  v_mfma_f32_16x16x32_bf16 v[228:231], v[136:139], v[16:19], 0
  v_mfma_f32_16x16x32_bf16 v[232:235], v[144:147], v[16:19], 0
  v_mfma_f32_16x16x32_bf16 v[236:239], v[152:155], v[16:19], 0
  v_mfma_f32_16x16x32_bf16 v[224:227], v[132:135], v[20:23], v[224:227]
  v_mfma_f32_16x16x32_bf16 v[228:231], v[140:143], v[20:23], v[228:231]
  v_mfma_f32_16x16x32_bf16 v[232:235], v[148:151], v[20:23], v[232:235]
  v_mfma_f32_16x16x32_bf16 v[236:239], v[156:159], v[20:23], v[236:239]
  buffer_load_dwordx4 v[128:131], v1, s[8:11], s54 offen offset:0 nt
  buffer_load_dwordx4 v[132:135], v1, s[8:11], s54 offen offset:128 nt
  buffer_load_dwordx4 v[136:139], v1, s[8:11], s54 offen offset:256 nt
  buffer_load_dwordx4 v[140:143], v1, s[8:11], s54 offen offset:384 nt
  buffer_load_dwordx4 v[144:147], v1, s[8:11], s54 offen offset:512 nt
  buffer_load_dwordx4 v[148:151], v1, s[8:11], s54 offen offset:640 nt
  buffer_load_dwordx4 v[152:155], v1, s[8:11], s54 offen offset:768 nt
  buffer_load_dwordx4 v[156:159], v1, s[8:11], s54 offen offset:896 nt
  s_add_u32 s54, s54, 0x8000
  s_nop 2
  v_add_f32_dpp v252, v225, v224 row_ror:8 row_mask:0xf bank_mask:0x3
  v_add_f32_dpp v252, v226, v227 row_ror:8 row_mask:0xf bank_mask:0xc
  v_add_f32_dpp v253, v229, v228 row_ror:8 row_mask:0xf bank_mask:0x3
  v_add_f32_dpp v253, v230, v231 row_ror:8 row_mask:0xf bank_mask:0xc
  v_add_f32_dpp v254, v233, v232 row_ror:8 row_mask:0xf bank_mask:0x3
  v_add_f32_dpp v254, v234, v235 row_ror:8 row_mask:0xf bank_mask:0xc
  v_add_f32_dpp v255, v237, v236 row_ror:8 row_mask:0xf bank_mask:0x3
  v_add_f32_dpp v255, v238, v239 row_ror:8 row_mask:0xf bank_mask:0xc
  ds_write_b128 v28, v[252:255] offset:2048
  v_max3_f32 v11, v252, v253, v24
  v_max3_f32 v24, v254, v255, v11
  v_mul_f32 v11, s52, v24
  v_sub_f32 v10, v8, v11
  v_exp_f32 v10, v10
  v_mov_b32 v8, v11
  v_fma_f32 v240, v252, s52, -v11
  v_fma_f32 v241, v253, s52, -v11
  v_fma_f32 v242, v254, s52, -v11
  v_fma_f32 v243, v255, s52, -v11
  v_exp_f32 v240, v240
  v_exp_f32 v241, v241
  v_exp_f32 v242, v242
  v_exp_f32 v243, v243
  v_fma_f32 v9, v9, v10, v240
  v_add_f32 v11, v241, v242
  v_add_f32 v9, v9, v243
  v_add_f32 v9, v9, v11
  s_waitcnt vmcnt(24)
  v_mfma_f32_16x16x32_bf16 v[224:227], v[160:163], v[16:19], 0
  v_mfma_f32_16x16x32_bf16 v[228:231], v[168:171], v[16:19], 0
  v_mfma_f32_16x16x32_bf16 v[232:235], v[176:179], v[16:19], 0
  v_mfma_f32_16x16x32_bf16 v[236:239], v[184:187], v[16:19], 0
  v_mfma_f32_16x16x32_bf16 v[224:227], v[164:167], v[20:23], v[224:227]
  v_mfma_f32_16x16x32_bf16 v[228:231], v[172:175], v[20:23], v[228:231]
  v_mfma_f32_16x16x32_bf16 v[232:235], v[180:183], v[20:23], v[232:235]
  v_mfma_f32_16x16x32_bf16 v[236:239], v[188:191], v[20:23], v[236:239]
  buffer_load_dwordx4 v[160:163], v1, s[8:11], s54 offen offset:0 nt
  buffer_load_dwordx4 v[164:167], v1, s[8:11], s54 offen offset:128 nt
  buffer_load_dwordx4 v[168:171], v1, s[8:11], s54 offen offset:256 nt
  buffer_load_dwordx4 v[172:175], v1, s[8:11], s54 offen offset:384 nt
  buffer_load_dwordx4 v[176:179], v1, s[8:11], s54 offen offset:512 nt
  buffer_load_dwordx4 v[180:183], v1, s[8:11], s54 offen offset:640 nt
  buffer_load_dwordx4 v[184:187], v1, s[8:11], s54 offen offset:768 nt
  buffer_load_dwordx4 v[188:191], v1, s[8:11], s54 offen offset:896 nt
  s_add_u32 s54, s54, 0x8000
  s_nop 2
  v_add_f32_dpp v252, v225, v224 row_ror:8 row_mask:0xf bank_mask:0x3
  v_add_f32_dpp v252, v226, v227 row_ror:8 row_mask:0xf bank_mask:0xc
  v_add_f32_dpp v253, v229, v228 row_ror:8 row_mask:0xf bank_mask:0x3
  v_add_f32_dpp v253, v230, v231 row_ror:8 row_mask:0xf bank_mask:0xc
  v_add_f32_dpp v254, v233, v232 row_ror:8 row_mask:0xf bank_mask:0x3
  v_add_f32_dpp v254, v234, v235 row_ror:8 row_mask:0xf bank_mask:0xc
  v_add_f32_dpp v255, v237, v236 row_ror:8 row_mask:0xf bank_mask:0x3
  v_add_f32_dpp v255, v238, v239 row_ror:8 row_mask:0xf bank_mask:0xc
  ds_write_b128 v28, v[252:255] offset:3072
  v_max3_f32 v11, v252, v253, v24
  v_max3_f32 v24, v254, v255, v11
  v_mul_f32 v11, s52, v24
  v_sub_f32 v10, v8, v11
  v_exp_f32 v10, v10
  v_mov_b32 v8, v11
  v_fma_f32 v240, v252, s52, -v11
  v_fma_f32 v241, v253, s52, -v11
  v_fma_f32 v242, v254, s52, -v11
  v_fma_f32 v243, v255, s52, -v11
  v_exp_f32 v240, v240
  v_exp_f32 v241, v241
  v_exp_f32 v242, v242
  v_exp_f32 v243, v243
  v_fma_f32 v9, v9, v10, v240
  v_add_f32 v11, v241, v242
  v_add_f32 v9, v9, v243
  v_add_f32 v9, v9, v11
  s_waitcnt vmcnt(24)
  v_mfma_f32_16x16x32_bf16 v[224:227], v[64:67], v[16:19], 0
  v_mfma_f32_16x16x32_bf16 v[228:231], v[72:75], v[16:19], 0
  v_mfma_f32_16x16x32_bf16 v[232:235], v[80:83], v[16:19], 0
  v_mfma_f32_16x16x32_bf16 v[236:239], v[88:91], v[16:19], 0
  v_mfma_f32_16x16x32_bf16 v[224:227], v[68:71], v[20:23], v[224:227]
  v_mfma_f32_16x16x32_bf16 v[228:231], v[76:79], v[20:23], v[228:231]
  v_mfma_f32_16x16x32_bf16 v[232:235], v[84:87], v[20:23], v[232:235]
  v_mfma_f32_16x16x32_bf16 v[236:239], v[92:95], v[20:23], v[236:239]
  s_cmp_ge_u32 s3, 2
  s_cbranch_scc1 L_ni2_1
  buffer_load_dwordx4 v[64:67], v1, s[8:11], s54 offen offset:0 nt
  buffer_load_dwordx4 v[68:71], v1, s[8:11], s54 offen offset:128 nt
  buffer_load_dwordx4 v[72:75], v1, s[8:11], s54 offen offset:256 nt
  buffer_load_dwordx4 v[76:79], v1, s[8:11], s54 offen offset:384 nt
  buffer_load_dwordx4 v[80:83], v1, s[8:11], s54 offen offset:512 nt
  buffer_load_dwordx4 v[84:87], v1, s[8:11], s54 offen offset:640 nt
  buffer_load_dwordx4 v[88:91], v1, s[8:11], s54 offen offset:768 nt
  buffer_load_dwordx4 v[92:95], v1, s[8:11], s54 offen offset:896 nt
  s_add_u32 s54, s54, 0x4000
  s_bitcmp1_b32 s54, 19
  s_cselect_b32 s55, 0x880000, 0
  s_xor_b32 s54, s54, s55
L_ni2_1:
  s_nop 2
  v_add_f32_dpp v252, v225, v224 row_ror:8 row_mask:0xf bank_mask:0x3
  v_add_f32_dpp v252, v226, v227 row_ror:8 row_mask:0xf bank_mask:0xc
  v_add_f32_dpp v253, v229, v228 row_ror:8 row_mask:0xf bank_mask:0x3
  v_add_f32_dpp v253, v230, v231 row_ror:8 row_mask:0xf bank_mask:0xc
  v_add_f32_dpp v254, v233, v232 row_ror:8 row_mask:0xf bank_mask:0x3
  v_add_f32_dpp v254, v234, v235 row_ror:8 row_mask:0xf bank_mask:0xc
  v_add_f32_dpp v255, v237, v236 row_ror:8 row_mask:0xf bank_mask:0x3
  v_add_f32_dpp v255, v238, v239 row_ror:8 row_mask:0xf bank_mask:0xc
  ds_write_b128 v28, v[252:255] offset:4096
  v_max3_f32 v11, v252, v253, v24
  v_max3_f32 v24, v254, v255, v11
  v_mul_f32 v11, s52, v24
  v_sub_f32 v10, v8, v11
  v_exp_f32 v10, v10
  v_mov_b32 v8, v11
  v_fma_f32 v240, v252, s52, -v11
  v_fma_f32 v241, v253, s52, -v11
  v_fma_f32 v242, v254, s52, -v11
  v_fma_f32 v243, v255, s52, -v11
  v_exp_f32 v240, v240
  v_exp_f32 v241, v241
  v_exp_f32 v242, v242
  v_exp_f32 v243, v243
  v_fma_f32 v9, v9, v10, v240
  v_add_f32 v11, v241, v242
  v_add_f32 v9, v9, v243
  v_add_f32 v9, v9, v11
  s_cmp_lt_u32 s3, 2
  s_cbranch_scc1 L_pw2_2
  s_waitcnt vmcnt(16)
L_pw2_2:
  s_waitcnt vmcnt(24)
  v_mfma_f32_16x16x32_bf16 v[224:227], v[96:99], v[16:19], 0
  v_mfma_f32_16x16x32_bf16 v[228:231], v[104:107], v[16:19], 0
  v_mfma_f32_16x16x32_bf16 v[232:235], v[112:115], v[16:19], 0
  v_mfma_f32_16x16x32_bf16 v[236:239], v[120:123], v[16:19], 0
  v_mfma_f32_16x16x32_bf16 v[224:227], v[100:103], v[20:23], v[224:227]
  v_mfma_f32_16x16x32_bf16 v[228:231], v[108:111], v[20:23], v[228:231]
  v_mfma_f32_16x16x32_bf16 v[232:235], v[116:119], v[20:23], v[232:235]
  v_mfma_f32_16x16x32_bf16 v[236:239], v[124:127], v[20:23], v[236:239]
  s_cmp_ge_u32 s3, 2
  s_cbranch_scc1 L_ni2_3
  buffer_load_dwordx4 v[96:99], v1, s[8:11], s54 offen offset:0 nt
  buffer_load_dwordx4 v[100:103], v1, s[8:11], s54 offen offset:128 nt
  buffer_load_dwordx4 v[104:107], v1, s[8:11], s54 offen offset:256 nt
  buffer_load_dwordx4 v[108:111], v1, s[8:11], s54 offen offset:384 nt
  buffer_load_dwordx4 v[112:115], v1, s[8:11], s54 offen offset:512 nt
  buffer_load_dwordx4 v[116:119], v1, s[8:11], s54 offen offset:640 nt
  buffer_load_dwordx4 v[120:123], v1, s[8:11], s54 offen offset:768 nt
  buffer_load_dwordx4 v[124:127], v1, s[8:11], s54 offen offset:896 nt
  s_add_u32 s54, s54, 0x4000
  s_bitcmp1_b32 s54, 19
  s_cselect_b32 s55, 0x880000, 0
  s_xor_b32 s54, s54, s55
L_ni2_3:
  s_nop 2
  v_add_f32_dpp v252, v225, v224 row_ror:8 row_mask:0xf bank_mask:0x3
  v_add_f32_dpp v252, v226, v227 row_ror:8 row_mask:0xf bank_mask:0xc
  v_add_f32_dpp v253, v229, v228 row_ror:8 row_mask:0xf bank_mask:0x3
  v_add_f32_dpp v253, v230, v231 row_ror:8 row_mask:0xf bank_mask:0xc
  v_add_f32_dpp v254, v233, v232 row_ror:8 row_mask:0xf bank_mask:0x3
  v_add_f32_dpp v254, v234, v235 row_ror:8 row_mask:0xf bank_mask:0xc
  v_add_f32_dpp v255, v237, v236 row_ror:8 row_mask:0xf bank_mask:0x3
  v_add_f32_dpp v255, v238, v239 row_ror:8 row_mask:0xf bank_mask:0xc
  ds_write_b128 v28, v[252:255] offset:5120
  v_max3_f32 v11, v252, v253, v24
  v_max3_f32 v24, v254, v255, v11
  v_mul_f32 v11, s52, v24
  v_sub_f32 v10, v8, v11
  v_exp_f32 v10, v10
  v_mov_b32 v8, v11
  v_fma_f32 v240, v252, s52, -v11
  v_fma_f32 v241, v253, s52, -v11
  v_fma_f32 v242, v254, s52, -v11
  v_fma_f32 v243, v255, s52, -v11
  v_exp_f32 v240, v240
  v_exp_f32 v241, v241
  v_exp_f32 v242, v242
  v_exp_f32 v243, v243
  v_fma_f32 v9, v9, v10, v240
  v_add_f32 v11, v241, v242
  v_add_f32 v9, v9, v243
  v_add_f32 v9, v9, v11
  s_cmp_lt_u32 s3, 2
  s_cbranch_scc1 L_pw2_4
  s_waitcnt vmcnt(8)
L_pw2_4:
  s_waitcnt vmcnt(24)
  v_mfma_f32_16x16x32_bf16 v[224:227], v[128:131], v[16:19], 0
  v_mfma_f32_16x16x32_bf16 v[228:231], v[136:139], v[16:19], 0
  v_mfma_f32_16x16x32_bf16 v[232:235], v[144:147], v[16:19], 0
  v_mfma_f32_16x16x32_bf16 v[236:239], v[152:155], v[16:19], 0
  v_mfma_f32_16x16x32_bf16 v[224:227], v[132:135], v[20:23], v[224:227]
  v_mfma_f32_16x16x32_bf16 v[228:231], v[140:143], v[20:23], v[228:231]
  v_mfma_f32_16x16x32_bf16 v[232:235], v[148:151], v[20:23], v[232:235]
  v_mfma_f32_16x16x32_bf16 v[236:239], v[156:159], v[20:23], v[236:239]
  s_nop 4
  v_add_f32_dpp v252, v225, v224 row_ror:8 row_mask:0xf bank_mask:0x3
  v_add_f32_dpp v252, v226, v227 row_ror:8 row_mask:0xf bank_mask:0xc
  v_add_f32_dpp v253, v229, v228 row_ror:8 row_mask:0xf bank_mask:0x3
  v_add_f32_dpp v253, v230, v231 row_ror:8 row_mask:0xf bank_mask:0xc
  v_add_f32_dpp v254, v233, v232 row_ror:8 row_mask:0xf bank_mask:0x3
  v_add_f32_dpp v254, v234, v235 row_ror:8 row_mask:0xf bank_mask:0xc
  v_add_f32_dpp v255, v237, v236 row_ror:8 row_mask:0xf bank_mask:0x3
  v_add_f32_dpp v255, v238, v239 row_ror:8 row_mask:0xf bank_mask:0xc
  ds_write_b128 v28, v[252:255] offset:6144
  v_max3_f32 v11, v252, v253, v24
  v_max3_f32 v24, v254, v255, v11
  v_mul_f32 v11, s52, v24
  v_sub_f32 v10, v8, v11
  v_exp_f32 v10, v10
  v_mov_b32 v8, v11
  v_fma_f32 v240, v252, s52, -v11
  v_fma_f32 v241, v253, s52, -v11
  v_fma_f32 v242, v254, s52, -v11
  v_fma_f32 v243, v255, s52, -v11
  v_exp_f32 v240, v240
  v_exp_f32 v241, v241
  v_exp_f32 v242, v242
  v_exp_f32 v243, v243
  v_fma_f32 v9, v9, v10, v240
  v_add_f32 v11, v241, v242
  v_add_f32 v9, v9, v243
  v_add_f32 v9, v9, v11
  s_cmp_lt_u32 s3, 2
  s_cbranch_scc1 L_pw2_5
  s_waitcnt vmcnt(0)
L_pw2_5:
  s_waitcnt vmcnt(16)
  v_mfma_f32_16x16x32_bf16 v[224:227], v[160:163], v[16:19], 0
  v_mfma_f32_16x16x32_bf16 v[228:231], v[168:171], v[16:19], 0
  v_mfma_f32_16x16x32_bf16 v[232:235], v[176:179], v[16:19], 0
  v_mfma_f32_16x16x32_bf16 v[236:239], v[184:187], v[16:19], 0
  v_mfma_f32_16x16x32_bf16 v[224:227], v[164:167], v[20:23], v[224:227]
  v_mfma_f32_16x16x32_bf16 v[228:231], v[172:175], v[20:23], v[228:231]
  v_mfma_f32_16x16x32_bf16 v[232:235], v[180:183], v[20:23], v[232:235]
  v_mfma_f32_16x16x32_bf16 v[236:239], v[188:191], v[20:23], v[236:239]
  s_nop 4
  v_add_f32_dpp v252, v225, v224 row_ror:8 row_mask:0xf bank_mask:0x3
  v_add_f32_dpp v252, v226, v227 row_ror:8 row_mask:0xf bank_mask:0xc
  v_add_f32_dpp v253, v229, v228 row_ror:8 row_mask:0xf bank_mask:0x3
  v_add_f32_dpp v253, v230, v231 row_ror:8 row_mask:0xf bank_mask:0xc
  v_add_f32_dpp v254, v233, v232 row_ror:8 row_mask:0xf bank_mask:0x3
  v_add_f32_dpp v254, v234, v235 row_ror:8 row_mask:0xf bank_mask:0xc
  v_add_f32_dpp v255, v237, v236 row_ror:8 row_mask:0xf bank_mask:0x3
  v_add_f32_dpp v255, v238, v239 row_ror:8 row_mask:0xf bank_mask:0xc
  ds_write_b128 v28, v[252:255] offset:7168
  v_max3_f32 v11, v252, v253, v24
  v_max3_f32 v24, v254, v255, v11
  v_mul_f32 v11, s52, v24
  v_sub_f32 v10, v8, v11
  v_exp_f32 v10, v10
  v_mov_b32 v8, v11
  v_fma_f32 v240, v252, s52, -v11
  v_fma_f32 v241, v253, s52, -v11
  v_fma_f32 v242, v254, s52, -v11
  v_fma_f32 v243, v255, s52, -v11
  v_exp_f32 v240, v240
  v_exp_f32 v241, v241
  v_exp_f32 v242, v242
  v_exp_f32 v243, v243
  v_fma_f32 v9, v9, v10, v240
  v_add_f32 v11, v241, v242
  v_add_f32 v9, v9, v243
  v_add_f32 v9, v9, v11
  s_mov_b32 s53, 12
  s_branch L_pdn
L_path0:
  s_barrier
  s_add_u32 s12, s36, s55
  s_addc_u32 s13, s37, 0
  s_mov_b32 s14, 0x880000
  s_mov_b32 s15, 0x00020000
  s_setprio 2
  s_cmp_ge_u32 s3, 2
  s_cbranch_scc1 L_pr0
  s_setprio 3
L_pr0:
  s_mov_b32 s50, 0x05040100
  s_mov_b32 s51, 0x07060302
  s_mov_b32 s60, 0xff00ff00
  s_mov_b32 s61, 0xff00ff00
  s_mov_b32 s7, 2
  s_mov_b32 s6, -32
  s_mov_b32 s27, 0
  s_mov_b32 s52, 0x3e0293ee
  v_lshlrev_b32 v192, 11, v15
  v_lshl_add_u32 v2, v14, 4, v192
  v_lshrrev_b32 v195, 3, v0
  v_and_b32 v193, 3, v14
  v_mul_u32_u24 v192, 1040, v193
  v_bfe_u32 v194, v14, 2, 1
  v_lshl_add_u32 v192, v194, 9, v192
  v_lshl_add_u32 v192, v195, 5, v192
  v_add_u32 v3, 140320, v192
  v_mul_u32_u24 v192, 544, v193
  v_lshl_add_u32 v192, v194, 8, v192
  v_lshl_add_u32 v192, v195, 5, v192
  s_mul_i32 s55, s3, 2176
  s_add_u32 s58, s55, 131616
  v_add_u32 v6, s58, v192
  v_lshlrev_b32 v192, 4, v0
  v_add_u32 v28, s57, v192
  v_add_u32 v4, 8192, v28
  v_and_b32 v194, 7, v14
  v_lshl_add_u32 v7, v194, 5, v13
  s_lshl_b32 s55, s3, 3
  v_add_u32 v5, s55, v7
  v_mov_b32 v25, 131072
  s_lshl_b32 s55, s3, 2
  v_add_u32 v29, s55, v13
  v_mov_b32 v8, 0xf149f2ca
  v_mov_b32 v9, 0
  v_mov_b32 v24, 0xf149f2ca
  s_barrier
  buffer_load_dwordx4 v[64:67], v1, s[8:11], s54 offen offset:0 nt
  buffer_load_dwordx4 v[68:71], v1, s[8:11], s54 offen offset:128 nt
  buffer_load_dwordx4 v[72:75], v1, s[8:11], s54 offen offset:256 nt
  buffer_load_dwordx4 v[76:79], v1, s[8:11], s54 offen offset:384 nt
  buffer_load_dwordx4 v[80:83], v1, s[8:11], s54 offen offset:512 nt
  buffer_load_dwordx4 v[84:87], v1, s[8:11], s54 offen offset:640 nt
  buffer_load_dwordx4 v[88:91], v1, s[8:11], s54 offen offset:768 nt
  buffer_load_dwordx4 v[92:95], v1, s[8:11], s54 offen offset:896 nt
  s_add_u32 s54, s54, 0x8000
  buffer_load_dwordx4 v[96:99], v1, s[8:11], s54 offen offset:0 nt
  buffer_load_dwordx4 v[100:103], v1, s[8:11], s54 offen offset:128 nt
  buffer_load_dwordx4 v[104:107], v1, s[8:11], s54 offen offset:256 nt
  buffer_load_dwordx4 v[108:111], v1, s[8:11], s54 offen offset:384 nt
  buffer_load_dwordx4 v[112:115], v1, s[8:11], s54 offen offset:512 nt
  buffer_load_dwordx4 v[116:119], v1, s[8:11], s54 offen offset:640 nt
  buffer_load_dwordx4 v[120:123], v1, s[8:11], s54 offen offset:768 nt
  buffer_load_dwordx4 v[124:127], v1, s[8:11], s54 offen offset:896 nt
  s_add_u32 s54, s54, 0x8000
L_wq0:
  ds_read_b32 v11, v13 offset:512
  s_waitcnt lgkmcnt(0)
  v_readfirstlane_b32 s55, v11
  s_cmp_ge_u32 s55, 4
  s_cbranch_scc1 L_wq0_d
  s_sleep 1
  s_branch L_wq0
L_wq0_d:
  ds_read_b128 v[192:195], v3 offset:0
  ds_read_b128 v[196:199], v3 offset:16
  ds_read_b128 v[200:203], v3 offset:8320
  ds_read_b128 v[204:207], v3 offset:8336
  ds_read_b128 v[208:211], v3 offset:256
  ds_read_b128 v[212:215], v3 offset:272
  ds_read_b128 v[216:219], v3 offset:8576
  ds_read_b128 v[220:223], v3 offset:8592
  s_waitcnt lgkmcnt(4)
  v_pk_add_f32 v[192:193], v[192:193], v[200:201]
  v_pk_add_f32 v[194:195], v[194:195], v[202:203]
  v_pk_add_f32 v[196:197], v[196:197], v[204:205]
  v_pk_add_f32 v[198:199], v[198:199], v[206:207]
  v_cvt_pk_bf16_f32 v16, v192, v193
  v_cvt_pk_bf16_f32 v17, v194, v195
  v_cvt_pk_bf16_f32 v18, v196, v197
  v_cvt_pk_bf16_f32 v19, v198, v199
  s_waitcnt lgkmcnt(0)
  v_pk_add_f32 v[208:209], v[208:209], v[216:217]
  v_pk_add_f32 v[210:211], v[210:211], v[218:219]
  v_pk_add_f32 v[212:213], v[212:213], v[220:221]
  v_pk_add_f32 v[214:215], v[214:215], v[222:223]
  v_cvt_pk_bf16_f32 v20, v208, v209
  v_cvt_pk_bf16_f32 v21, v210, v211
  v_cvt_pk_bf16_f32 v22, v212, v213
  v_cvt_pk_bf16_f32 v23, v214, v215
  s_waitcnt vmcnt(8)
  buffer_load_dwordx4 v[128:131], v1, s[8:11], s54 offen offset:0 nt
  buffer_load_dwordx4 v[132:135], v1, s[8:11], s54 offen offset:128 nt
  buffer_load_dwordx4 v[136:139], v1, s[8:11], s54 offen offset:256 nt
  buffer_load_dwordx4 v[140:143], v1, s[8:11], s54 offen offset:384 nt
  buffer_load_dwordx4 v[144:147], v1, s[8:11], s54 offen offset:512 nt
  buffer_load_dwordx4 v[148:151], v1, s[8:11], s54 offen offset:640 nt
  buffer_load_dwordx4 v[152:155], v1, s[8:11], s54 offen offset:768 nt
  buffer_load_dwordx4 v[156:159], v1, s[8:11], s54 offen offset:896 nt
  s_add_u32 s54, s54, 0x8000
  v_mfma_f32_16x16x32_bf16 v[224:227], v[64:67], v[16:19], 0
  v_mfma_f32_16x16x32_bf16 v[228:231], v[72:75], v[16:19], 0
  v_mfma_f32_16x16x32_bf16 v[232:235], v[80:83], v[16:19], 0
  v_mfma_f32_16x16x32_bf16 v[236:239], v[88:91], v[16:19], 0
  v_mfma_f32_16x16x32_bf16 v[224:227], v[68:71], v[20:23], v[224:227]
  v_mfma_f32_16x16x32_bf16 v[228:231], v[76:79], v[20:23], v[228:231]
  v_mfma_f32_16x16x32_bf16 v[232:235], v[84:87], v[20:23], v[232:235]
  v_mfma_f32_16x16x32_bf16 v[236:239], v[92:95], v[20:23], v[236:239]
  s_nop 4
  v_add_f32_dpp v252, v225, v224 row_ror:8 row_mask:0xf bank_mask:0x3
  v_add_f32_dpp v252, v226, v227 row_ror:8 row_mask:0xf bank_mask:0xc
  v_add_f32_dpp v253, v229, v228 row_ror:8 row_mask:0xf bank_mask:0x3
  v_add_f32_dpp v253, v230, v231 row_ror:8 row_mask:0xf bank_mask:0xc
  v_add_f32_dpp v254, v233, v232 row_ror:8 row_mask:0xf bank_mask:0x3
  v_add_f32_dpp v254, v234, v235 row_ror:8 row_mask:0xf bank_mask:0xc
  v_add_f32_dpp v255, v237, v236 row_ror:8 row_mask:0xf bank_mask:0x3
  v_add_f32_dpp v255, v238, v239 row_ror:8 row_mask:0xf bank_mask:0xc
  ds_write_b128 v28, v[252:255] offset:0
  v_max3_f32 v11, v252, v253, v24
  v_max3_f32 v24, v254, v255, v11
  v_mul_f32 v11, s52, v24
  v_sub_f32 v10, v8, v11
  v_exp_f32 v10, v10
  v_mov_b32 v8, v11
  v_fma_f32 v240, v252, s52, -v11
  v_fma_f32 v241, v253, s52, -v11
  v_fma_f32 v242, v254, s52, -v11
  v_fma_f32 v243, v255, s52, -v11
  v_exp_f32 v240, v240
  v_exp_f32 v241, v241
  v_exp_f32 v242, v242
  v_exp_f32 v243, v243
  v_fma_f32 v9, v9, v10, v240
  v_add_f32 v11, v241, v242
  v_add_f32 v9, v9, v243
  v_add_f32 v9, v9, v11
  s_waitcnt vmcnt(8)
  buffer_load_dwordx4 v[160:163], v1, s[8:11], s54 offen offset:0 nt
  buffer_load_dwordx4 v[164:167], v1, s[8:11], s54 offen offset:128 nt
  buffer_load_dwordx4 v[168:171], v1, s[8:11], s54 offen offset:256 nt
  buffer_load_dwordx4 v[172:175], v1, s[8:11], s54 offen offset:384 nt
  buffer_load_dwordx4 v[176:179], v1, s[8:11], s54 offen offset:512 nt
  buffer_load_dwordx4 v[180:183], v1, s[8:11], s54 offen offset:640 nt
  buffer_load_dwordx4 v[184:187], v1, s[8:11], s54 offen offset:768 nt
  buffer_load_dwordx4 v[188:191], v1, s[8:11], s54 offen offset:896 nt
  s_add_u32 s54, s54, 0x8000
  v_mfma_f32_16x16x32_bf16 v[224:227], v[96:99], v[16:19], 0
  v_mfma_f32_16x16x32_bf16 v[228:231], v[104:107], v[16:19], 0
  v_mfma_f32_16x16x32_bf16 v[232:235], v[112:115], v[16:19], 0
  v_mfma_f32_16x16x32_bf16 v[236:239], v[120:123], v[16:19], 0
  v_mfma_f32_16x16x32_bf16 v[224:227], v[100:103], v[20:23], v[224:227]
  v_mfma_f32_16x16x32_bf16 v[228:231], v[108:111], v[20:23], v[228:231]
  v_mfma_f32_16x16x32_bf16 v[232:235], v[116:119], v[20:23], v[232:235]
  v_mfma_f32_16x16x32_bf16 v[236:239], v[124:127], v[20:23], v[236:239]
  s_nop 4
  v_add_f32_dpp v252, v225, v224 row_ror:8 row_mask:0xf bank_mask:0x3
  v_add_f32_dpp v252, v226, v227 row_ror:8 row_mask:0xf bank_mask:0xc
  v_add_f32_dpp v253, v229, v228 row_ror:8 row_mask:0xf bank_mask:0x3
  v_add_f32_dpp v253, v230, v231 row_ror:8 row_mask:0xf bank_mask:0xc
  v_add_f32_dpp v254, v233, v232 row_ror:8 row_mask:0xf bank_mask:0x3
  v_add_f32_dpp v254, v234, v235 row_ror:8 row_mask:0xf bank_mask:0xc
  v_add_f32_dpp v255, v237, v236 row_ror:8 row_mask:0xf bank_mask:0x3
  v_add_f32_dpp v255, v238, v239 row_ror:8 row_mask:0xf bank_mask:0xc
  ds_write_b128 v28, v[252:255] offset:1024
  v_max3_f32 v11, v252, v253, v24
  v_max3_f32 v24, v254, v255, v11
  v_mul_f32 v11, s52, v24
  v_sub_f32 v10, v8, v11
  v_exp_f32 v10, v10
  v_mov_b32 v8, v11
  v_fma_f32 v240, v252, s52, -v11
  v_fma_f32 v241, v253, s52, -v11
  v_fma_f32 v242, v254, s52, -v11
  v_fma_f32 v243, v255, s52, -v11
  v_exp_f32 v240, v240
  v_exp_f32 v241, v241
  v_exp_f32 v242, v242
  v_exp_f32 v243, v243
  v_fma_f32 v9, v9, v10, v240
  v_add_f32 v11, v241, v242
  v_add_f32 v9, v9, v243
  v_add_f32 v9, v9, v11
  s_waitcnt vmcnt(8)
  buffer_load_dwordx4 v[64:67], v1, s[8:11], s54 offen offset:0 nt
  buffer_load_dwordx4 v[68:71], v1, s[8:11], s54 offen offset:128 nt
  buffer_load_dwordx4 v[72:75], v1, s[8:11], s54 offen offset:256 nt
  buffer_load_dwordx4 v[76:79], v1, s[8:11], s54 offen offset:384 nt
  buffer_load_dwordx4 v[80:83], v1, s[8:11], s54 offen offset:512 nt
  buffer_load_dwordx4 v[84:87], v1, s[8:11], s54 offen offset:640 nt
  buffer_load_dwordx4 v[88:91], v1, s[8:11], s54 offen offset:768 nt
  buffer_load_dwordx4 v[92:95], v1, s[8:11], s54 offen offset:896 nt
  s_add_u32 s54, s54, 0x8000
  v_mfma_f32_16x16x32_bf16 v[224:227], v[128:131], v[16:19], 0
  v_mfma_f32_16x16x32_bf16 v[228:231], v[136:139], v[16:19], 0
  v_mfma_f32_16x16x32_bf16 v[232:235], v[144:147], v[16:19], 0
  v_mfma_f32_16x16x32_bf16 v[236:239], v[152:155], v[16:19], 0
  v_mfma_f32_16x16x32_bf16 v[224:227], v[132:135], v[20:23], v[224:227]
  v_mfma_f32_16x16x32_bf16 v[228:231], v[140:143], v[20:23], v[228:231]
  v_mfma_f32_16x16x32_bf16 v[232:235], v[148:151], v[20:23], v[232:235]
  v_mfma_f32_16x16x32_bf16 v[236:239], v[156:159], v[20:23], v[236:239]
  s_nop 4
  v_add_f32_dpp v252, v225, v224 row_ror:8 row_mask:0xf bank_mask:0x3
  v_add_f32_dpp v252, v226, v227 row_ror:8 row_mask:0xf bank_mask:0xc
  v_add_f32_dpp v253, v229, v228 row_ror:8 row_mask:0xf bank_mask:0x3
  v_add_f32_dpp v253, v230, v231 row_ror:8 row_mask:0xf bank_mask:0xc
  v_add_f32_dpp v254, v233, v232 row_ror:8 row_mask:0xf bank_mask:0x3
  v_add_f32_dpp v254, v234, v235 row_ror:8 row_mask:0xf bank_mask:0xc
  v_add_f32_dpp v255, v237, v236 row_ror:8 row_mask:0xf bank_mask:0x3
  v_add_f32_dpp v255, v238, v239 row_ror:8 row_mask:0xf bank_mask:0xc
  ds_write_b128 v28, v[252:255] offset:2048
  v_max3_f32 v11, v252, v253, v24
  v_max3_f32 v24, v254, v255, v11
  v_mul_f32 v11, s52, v24
  v_sub_f32 v10, v8, v11
  v_exp_f32 v10, v10
  v_mov_b32 v8, v11
  v_fma_f32 v240, v252, s52, -v11
  v_fma_f32 v241, v253, s52, -v11
  v_fma_f32 v242, v254, s52, -v11
  v_fma_f32 v243, v255, s52, -v11
  v_exp_f32 v240, v240
  v_exp_f32 v241, v241
  v_exp_f32 v242, v242
  v_exp_f32 v243, v243
  v_fma_f32 v9, v9, v10, v240
  v_add_f32 v11, v241, v242
  v_add_f32 v9, v9, v243
  v_add_f32 v9, v9, v11
  s_waitcnt vmcnt(8)
  buffer_load_dwordx4 v[96:99], v1, s[8:11], s54 offen offset:0 nt
  buffer_load_dwordx4 v[100:103], v1, s[8:11], s54 offen offset:128 nt
  buffer_load_dwordx4 v[104:107], v1, s[8:11], s54 offen offset:256 nt
  buffer_load_dwordx4 v[108:111], v1, s[8:11], s54 offen offset:384 nt
  buffer_load_dwordx4 v[112:115], v1, s[8:11], s54 offen offset:512 nt
  buffer_load_dwordx4 v[116:119], v1, s[8:11], s54 offen offset:640 nt
  buffer_load_dwordx4 v[120:123], v1, s[8:11], s54 offen offset:768 nt
  buffer_load_dwordx4 v[124:127], v1, s[8:11], s54 offen offset:896 nt
  s_add_u32 s54, s54, 0x8000
  v_mfma_f32_16x16x32_bf16 v[224:227], v[160:163], v[16:19], 0
  v_mfma_f32_16x16x32_bf16 v[228:231], v[168:171], v[16:19], 0
  v_mfma_f32_16x16x32_bf16 v[232:235], v[176:179], v[16:19], 0
  v_mfma_f32_16x16x32_bf16 v[236:239], v[184:187], v[16:19], 0
  v_mfma_f32_16x16x32_bf16 v[224:227], v[164:167], v[20:23], v[224:227]
  v_mfma_f32_16x16x32_bf16 v[228:231], v[172:175], v[20:23], v[228:231]
  v_mfma_f32_16x16x32_bf16 v[232:235], v[180:183], v[20:23], v[232:235]
  v_mfma_f32_16x16x32_bf16 v[236:239], v[188:191], v[20:23], v[236:239]
  s_nop 4
  v_add_f32_dpp v252, v225, v224 row_ror:8 row_mask:0xf bank_mask:0x3
  v_add_f32_dpp v252, v226, v227 row_ror:8 row_mask:0xf bank_mask:0xc
  v_add_f32_dpp v253, v229, v228 row_ror:8 row_mask:0xf bank_mask:0x3
  v_add_f32_dpp v253, v230, v231 row_ror:8 row_mask:0xf bank_mask:0xc
  v_add_f32_dpp v254, v233, v232 row_ror:8 row_mask:0xf bank_mask:0x3
  v_add_f32_dpp v254, v234, v235 row_ror:8 row_mask:0xf bank_mask:0xc
  v_add_f32_dpp v255, v237, v236 row_ror:8 row_mask:0xf bank_mask:0x3
  v_add_f32_dpp v255, v238, v239 row_ror:8 row_mask:0xf bank_mask:0xc
  ds_write_b128 v28, v[252:255] offset:3072
  v_max3_f32 v11, v252, v253, v24
  v_max3_f32 v24, v254, v255, v11
  v_mul_f32 v11, s52, v24
  v_sub_f32 v10, v8, v11
  v_exp_f32 v10, v10
  v_mov_b32 v8, v11
  v_fma_f32 v240, v252, s52, -v11
  v_fma_f32 v241, v253, s52, -v11
  v_fma_f32 v242, v254, s52, -v11
  v_fma_f32 v243, v255, s52, -v11
  v_exp_f32 v240, v240
  v_exp_f32 v241, v241
  v_exp_f32 v242, v242
  v_exp_f32 v243, v243
  v_fma_f32 v9, v9, v10, v240
  v_add_f32 v11, v241, v242
  v_add_f32 v9, v9, v243
  v_add_f32 v9, v9, v11
  s_waitcnt vmcnt(8)
  buffer_load_dwordx4 v[128:131], v1, s[8:11], s54 offen offset:0 nt
  buffer_load_dwordx4 v[132:135], v1, s[8:11], s54 offen offset:128 nt
  buffer_load_dwordx4 v[136:139], v1, s[8:11], s54 offen offset:256 nt
  buffer_load_dwordx4 v[140:143], v1, s[8:11], s54 offen offset:384 nt
  buffer_load_dwordx4 v[144:147], v1, s[8:11], s54 offen offset:512 nt
  buffer_load_dwordx4 v[148:151], v1, s[8:11], s54 offen offset:640 nt
  buffer_load_dwordx4 v[152:155], v1, s[8:11], s54 offen offset:768 nt
  buffer_load_dwordx4 v[156:159], v1, s[8:11], s54 offen offset:896 nt
  s_add_u32 s54, s54, 0x8000
  v_mfma_f32_16x16x32_bf16 v[224:227], v[64:67], v[16:19], 0
  v_mfma_f32_16x16x32_bf16 v[228:231], v[72:75], v[16:19], 0
  v_mfma_f32_16x16x32_bf16 v[232:235], v[80:83], v[16:19], 0
  v_mfma_f32_16x16x32_bf16 v[236:239], v[88:91], v[16:19], 0
  v_mfma_f32_16x16x32_bf16 v[224:227], v[68:71], v[20:23], v[224:227]
  v_mfma_f32_16x16x32_bf16 v[228:231], v[76:79], v[20:23], v[228:231]
  v_mfma_f32_16x16x32_bf16 v[232:235], v[84:87], v[20:23], v[232:235]
  v_mfma_f32_16x16x32_bf16 v[236:239], v[92:95], v[20:23], v[236:239]
  s_nop 4
  v_add_f32_dpp v252, v225, v224 row_ror:8 row_mask:0xf bank_mask:0x3
  v_add_f32_dpp v252, v226, v227 row_ror:8 row_mask:0xf bank_mask:0xc
  v_add_f32_dpp v253, v229, v228 row_ror:8 row_mask:0xf bank_mask:0x3
  v_add_f32_dpp v253, v230, v231 row_ror:8 row_mask:0xf bank_mask:0xc
  v_add_f32_dpp v254, v233, v232 row_ror:8 row_mask:0xf bank_mask:0x3
  v_add_f32_dpp v254, v234, v235 row_ror:8 row_mask:0xf bank_mask:0xc
  v_add_f32_dpp v255, v237, v236 row_ror:8 row_mask:0xf bank_mask:0x3
  v_add_f32_dpp v255, v238, v239 row_ror:8 row_mask:0xf bank_mask:0xc
  ds_write_b128 v28, v[252:255] offset:4096
  v_max3_f32 v11, v252, v253, v24
  v_max3_f32 v24, v254, v255, v11
  v_mul_f32 v11, s52, v24
  v_sub_f32 v10, v8, v11
  v_exp_f32 v10, v10
  v_mov_b32 v8, v11
  v_fma_f32 v240, v252, s52, -v11
  v_fma_f32 v241, v253, s52, -v11
  v_fma_f32 v242, v254, s52, -v11
  v_fma_f32 v243, v255, s52, -v11
  v_exp_f32 v240, v240
  v_exp_f32 v241, v241
  v_exp_f32 v242, v242
  v_exp_f32 v243, v243
  v_fma_f32 v9, v9, v10, v240
  v_add_f32 v11, v241, v242
  v_add_f32 v9, v9, v243
  v_add_f32 v9, v9, v11
  s_waitcnt vmcnt(8)
  buffer_load_dwordx4 v[160:163], v1, s[8:11], s54 offen offset:0 nt
  buffer_load_dwordx4 v[164:167], v1, s[8:11], s54 offen offset:128 nt
  buffer_load_dwordx4 v[168:171], v1, s[8:11], s54 offen offset:256 nt
  buffer_load_dwordx4 v[172:175], v1, s[8:11], s54 offen offset:384 nt
  buffer_load_dwordx4 v[176:179], v1, s[8:11], s54 offen offset:512 nt
  buffer_load_dwordx4 v[180:183], v1, s[8:11], s54 offen offset:640 nt
  buffer_load_dwordx4 v[184:187], v1, s[8:11], s54 offen offset:768 nt
  buffer_load_dwordx4 v[188:191], v1, s[8:11], s54 offen offset:896 nt
  s_add_u32 s54, s54, 0x8000
  v_mfma_f32_16x16x32_bf16 v[224:227], v[96:99], v[16:19], 0
  v_mfma_f32_16x16x32_bf16 v[228:231], v[104:107], v[16:19], 0
  v_mfma_f32_16x16x32_bf16 v[232:235], v[112:115], v[16:19], 0
  v_mfma_f32_16x16x32_bf16 v[236:239], v[120:123], v[16:19], 0
  v_mfma_f32_16x16x32_bf16 v[224:227], v[100:103], v[20:23], v[224:227]
  v_mfma_f32_16x16x32_bf16 v[228:231], v[108:111], v[20:23], v[228:231]
  v_mfma_f32_16x16x32_bf16 v[232:235], v[116:119], v[20:23], v[232:235]
  v_mfma_f32_16x16x32_bf16 v[236:239], v[124:127], v[20:23], v[236:239]
  s_nop 4
  v_add_f32_dpp v252, v225, v224 row_ror:8 row_mask:0xf bank_mask:0x3
  v_add_f32_dpp v252, v226, v227 row_ror:8 row_mask:0xf bank_mask:0xc
  v_add_f32_dpp v253, v229, v228 row_ror:8 row_mask:0xf bank_mask:0x3
  v_add_f32_dpp v253, v230, v231 row_ror:8 row_mask:0xf bank_mask:0xc
  v_add_f32_dpp v254, v233, v232 row_ror:8 row_mask:0xf bank_mask:0x3
  v_add_f32_dpp v254, v234, v235 row_ror:8 row_mask:0xf bank_mask:0xc
  v_add_f32_dpp v255, v237, v236 row_ror:8 row_mask:0xf bank_mask:0x3
  v_add_f32_dpp v255, v238, v239 row_ror:8 row_mask:0xf bank_mask:0xc
  ds_write_b128 v28, v[252:255] offset:5120
  v_max3_f32 v11, v252, v253, v24
  v_max3_f32 v24, v254, v255, v11
  v_mul_f32 v11, s52, v24
  v_sub_f32 v10, v8, v11
  v_exp_f32 v10, v10
  v_mov_b32 v8, v11
  v_fma_f32 v240, v252, s52, -v11
  v_fma_f32 v241, v253, s52, -v11
  v_fma_f32 v242, v254, s52, -v11
  v_fma_f32 v243, v255, s52, -v11
  v_exp_f32 v240, v240
  v_exp_f32 v241, v241
  v_exp_f32 v242, v242
  v_exp_f32 v243, v243
  v_fma_f32 v9, v9, v10, v240
  v_add_f32 v11, v241, v242
  v_add_f32 v9, v9, v243
  v_add_f32 v9, v9, v11
  s_waitcnt vmcnt(8)
  s_cmp_ge_u32 s3, 2
  s_cbranch_scc1 L_ni0_1
  buffer_load_dwordx4 v[64:67], v1, s[8:11], s54 offen offset:0 nt
  buffer_load_dwordx4 v[68:71], v1, s[8:11], s54 offen offset:128 nt
  buffer_load_dwordx4 v[72:75], v1, s[8:11], s54 offen offset:256 nt
  buffer_load_dwordx4 v[76:79], v1, s[8:11], s54 offen offset:384 nt
  buffer_load_dwordx4 v[80:83], v1, s[8:11], s54 offen offset:512 nt
  buffer_load_dwordx4 v[84:87], v1, s[8:11], s54 offen offset:640 nt
  buffer_load_dwordx4 v[88:91], v1, s[8:11], s54 offen offset:768 nt
  buffer_load_dwordx4 v[92:95], v1, s[8:11], s54 offen offset:896 nt
  s_add_u32 s54, s54, 0x4000
  s_bitcmp1_b32 s54, 19
  s_cselect_b32 s55, 0x880000, 0
  s_xor_b32 s54, s54, s55
L_ni0_1:
  v_mfma_f32_16x16x32_bf16 v[224:227], v[128:131], v[16:19], 0
  v_mfma_f32_16x16x32_bf16 v[228:231], v[136:139], v[16:19], 0
  v_mfma_f32_16x16x32_bf16 v[232:235], v[144:147], v[16:19], 0
  v_mfma_f32_16x16x32_bf16 v[236:239], v[152:155], v[16:19], 0
  v_mfma_f32_16x16x32_bf16 v[224:227], v[132:135], v[20:23], v[224:227]
  v_mfma_f32_16x16x32_bf16 v[228:231], v[140:143], v[20:23], v[228:231]
  v_mfma_f32_16x16x32_bf16 v[232:235], v[148:151], v[20:23], v[232:235]
  v_mfma_f32_16x16x32_bf16 v[236:239], v[156:159], v[20:23], v[236:239]
  s_nop 4
  v_add_f32_dpp v252, v225, v224 row_ror:8 row_mask:0xf bank_mask:0x3
  v_add_f32_dpp v252, v226, v227 row_ror:8 row_mask:0xf bank_mask:0xc
  v_add_f32_dpp v253, v229, v228 row_ror:8 row_mask:0xf bank_mask:0x3
  v_add_f32_dpp v253, v230, v231 row_ror:8 row_mask:0xf bank_mask:0xc
  v_add_f32_dpp v254, v233, v232 row_ror:8 row_mask:0xf bank_mask:0x3
  v_add_f32_dpp v254, v234, v235 row_ror:8 row_mask:0xf bank_mask:0xc
  v_add_f32_dpp v255, v237, v236 row_ror:8 row_mask:0xf bank_mask:0x3
  v_add_f32_dpp v255, v238, v239 row_ror:8 row_mask:0xf bank_mask:0xc
  ds_write_b128 v28, v[252:255] offset:6144
  v_max3_f32 v11, v252, v253, v24
  v_max3_f32 v24, v254, v255, v11
  v_mul_f32 v11, s52, v24
  v_sub_f32 v10, v8, v11
  v_exp_f32 v10, v10
  v_mov_b32 v8, v11
  v_fma_f32 v240, v252, s52, -v11
  v_fma_f32 v241, v253, s52, -v11
  v_fma_f32 v242, v254, s52, -v11
  v_fma_f32 v243, v255, s52, -v11
  v_exp_f32 v240, v240
  v_exp_f32 v241, v241
  v_exp_f32 v242, v242
  v_exp_f32 v243, v243
  v_fma_f32 v9, v9, v10, v240
  v_add_f32 v11, v241, v242
  v_add_f32 v9, v9, v243
  v_add_f32 v9, v9, v11
  s_cmp_lt_u32 s3, 2
  s_cbranch_scc1 L_pw0_2
  s_waitcnt vmcnt(0)
L_pw0_2:
  s_waitcnt vmcnt(8)
  s_cmp_ge_u32 s3, 2
  s_cbranch_scc1 L_ni0_3
  buffer_load_dwordx4 v[96:99], v1, s[8:11], s54 offen offset:0 nt
  buffer_load_dwordx4 v[100:103], v1, s[8:11], s54 offen offset:128 nt
  buffer_load_dwordx4 v[104:107], v1, s[8:11], s54 offen offset:256 nt
  buffer_load_dwordx4 v[108:111], v1, s[8:11], s54 offen offset:384 nt
  buffer_load_dwordx4 v[112:115], v1, s[8:11], s54 offen offset:512 nt
  buffer_load_dwordx4 v[116:119], v1, s[8:11], s54 offen offset:640 nt
  buffer_load_dwordx4 v[120:123], v1, s[8:11], s54 offen offset:768 nt
  buffer_load_dwordx4 v[124:127], v1, s[8:11], s54 offen offset:896 nt
  s_add_u32 s54, s54, 0x4000
  s_bitcmp1_b32 s54, 19
  s_cselect_b32 s55, 0x880000, 0
  s_xor_b32 s54, s54, s55
L_ni0_3:
  v_mfma_f32_16x16x32_bf16 v[224:227], v[160:163], v[16:19], 0
  v_mfma_f32_16x16x32_bf16 v[228:231], v[168:171], v[16:19], 0
  v_mfma_f32_16x16x32_bf16 v[232:235], v[176:179], v[16:19], 0
  v_mfma_f32_16x16x32_bf16 v[236:239], v[184:187], v[16:19], 0
  v_mfma_f32_16x16x32_bf16 v[224:227], v[164:167], v[20:23], v[224:227]
  v_mfma_f32_16x16x32_bf16 v[228:231], v[172:175], v[20:23], v[228:231]
  v_mfma_f32_16x16x32_bf16 v[232:235], v[180:183], v[20:23], v[232:235]
  v_mfma_f32_16x16x32_bf16 v[236:239], v[188:191], v[20:23], v[236:239]
  s_nop 4
  v_add_f32_dpp v252, v225, v224 row_ror:8 row_mask:0xf bank_mask:0x3
  v_add_f32_dpp v252, v226, v227 row_ror:8 row_mask:0xf bank_mask:0xc
  v_add_f32_dpp v253, v229, v228 row_ror:8 row_mask:0xf bank_mask:0x3
  v_add_f32_dpp v253, v230, v231 row_ror:8 row_mask:0xf bank_mask:0xc
  v_add_f32_dpp v254, v233, v232 row_ror:8 row_mask:0xf bank_mask:0x3
  v_add_f32_dpp v254, v234, v235 row_ror:8 row_mask:0xf bank_mask:0xc
  v_add_f32_dpp v255, v237, v236 row_ror:8 row_mask:0xf bank_mask:0x3
  v_add_f32_dpp v255, v238, v239 row_ror:8 row_mask:0xf bank_mask:0xc
  ds_write_b128 v28, v[252:255] offset:7168
  v_max3_f32 v11, v252, v253, v24
  v_max3_f32 v24, v254, v255, v11
  v_mul_f32 v11, s52, v24
  v_sub_f32 v10, v8, v11
  v_exp_f32 v10, v10
  v_mov_b32 v8, v11
  v_fma_f32 v240, v252, s52, -v11
  v_fma_f32 v241, v253, s52, -v11
  v_fma_f32 v242, v254, s52, -v11
  v_fma_f32 v243, v255, s52, -v11
  v_exp_f32 v240, v240
  v_exp_f32 v241, v241
  v_exp_f32 v242, v242
  v_exp_f32 v243, v243
  v_fma_f32 v9, v9, v10, v240
  v_add_f32 v11, v241, v242
  v_add_f32 v9, v9, v243
  v_add_f32 v9, v9, v11
  s_mov_b32 s53, 12
L_pdn:
  s_cmp_ge_u32 s3, 2
  s_cbranch_scc1 L_kfin
L_wp:
  ds_read_b32 v11, v13 offset:516
  s_waitcnt lgkmcnt(0)
  v_readfirstlane_b32 s55, v11
  s_cmp_ge_u32 s55, 2
  s_cbranch_scc1 L_wp_d
  s_sleep 1
  s_branch L_wp
L_wp_d:
  s_cmp_eq_u32 s53, 12
  s_cbranch_scc1 L_kloop
  s_mov_b32 s53, 12
  s_waitcnt vmcnt(24)
  v_mfma_f32_16x16x32_bf16 v[224:227], v[64:67], v[16:19], 0
  v_mfma_f32_16x16x32_bf16 v[228:231], v[72:75], v[16:19], 0
  v_mfma_f32_16x16x32_bf16 v[232:235], v[80:83], v[16:19], 0
  v_mfma_f32_16x16x32_bf16 v[236:239], v[88:91], v[16:19], 0
  v_mfma_f32_16x16x32_bf16 v[224:227], v[68:71], v[20:23], v[224:227]
  v_mfma_f32_16x16x32_bf16 v[228:231], v[76:79], v[20:23], v[228:231]
  v_mfma_f32_16x16x32_bf16 v[232:235], v[84:87], v[20:23], v[232:235]
  v_mfma_f32_16x16x32_bf16 v[236:239], v[92:95], v[20:23], v[236:239]
  s_nop 4
  v_add_f32_dpp v252, v225, v224 row_ror:8 row_mask:0xf bank_mask:0x3
  v_add_f32_dpp v252, v226, v227 row_ror:8 row_mask:0xf bank_mask:0xc
  v_add_f32_dpp v253, v229, v228 row_ror:8 row_mask:0xf bank_mask:0x3
  v_add_f32_dpp v253, v230, v231 row_ror:8 row_mask:0xf bank_mask:0xc
  v_add_f32_dpp v254, v233, v232 row_ror:8 row_mask:0xf bank_mask:0x3
  v_add_f32_dpp v254, v234, v235 row_ror:8 row_mask:0xf bank_mask:0xc
  v_add_f32_dpp v255, v237, v236 row_ror:8 row_mask:0xf bank_mask:0x3
  v_add_f32_dpp v255, v238, v239 row_ror:8 row_mask:0xf bank_mask:0xc
  ds_write_b128 v4, v[252:255] offset:0
  v_max3_f32 v11, v252, v253, v24
  v_max3_f32 v24, v254, v255, v11
  v_mul_f32 v11, s52, v24
  v_sub_f32 v10, v8, v11
  v_exp_f32 v10, v10
  v_mov_b32 v8, v11
  v_fma_f32 v240, v252, s52, -v11
  v_fma_f32 v241, v253, s52, -v11
  v_fma_f32 v242, v254, s52, -v11
  v_fma_f32 v243, v255, s52, -v11
  v_exp_f32 v240, v240
  v_exp_f32 v241, v241
  v_exp_f32 v242, v242
  v_exp_f32 v243, v243
  v_fma_f32 v9, v9, v10, v240
  v_add_f32 v11, v241, v242
  v_add_f32 v9, v9, v243
  v_add_f32 v9, v9, v11
  s_waitcnt vmcnt(16)
  s_memrealtime s[20:21]
  ds_read_b64 v[30:31], v13 offset:26136
  v_mfma_f32_16x16x32_bf16 v[224:227], v[96:99], v[16:19], 0
  v_mfma_f32_16x16x32_bf16 v[228:231], v[104:107], v[16:19], 0
  v_mfma_f32_16x16x32_bf16 v[232:235], v[112:115], v[16:19], 0
  v_mfma_f32_16x16x32_bf16 v[236:239], v[120:123], v[16:19], 0
  v_mfma_f32_16x16x32_bf16 v[224:227], v[100:103], v[20:23], v[224:227]
  v_mfma_f32_16x16x32_bf16 v[228:231], v[108:111], v[20:23], v[228:231]
  v_mfma_f32_16x16x32_bf16 v[232:235], v[116:119], v[20:23], v[232:235]
  v_mfma_f32_16x16x32_bf16 v[236:239], v[124:127], v[20:23], v[236:239]
  s_nop 4
  v_add_f32_dpp v252, v225, v224 row_ror:8 row_mask:0xf bank_mask:0x3
  v_add_f32_dpp v252, v226, v227 row_ror:8 row_mask:0xf bank_mask:0xc
  v_add_f32_dpp v253, v229, v228 row_ror:8 row_mask:0xf bank_mask:0x3
  v_add_f32_dpp v253, v230, v231 row_ror:8 row_mask:0xf bank_mask:0xc
  v_add_f32_dpp v254, v233, v232 row_ror:8 row_mask:0xf bank_mask:0x3
  v_add_f32_dpp v254, v234, v235 row_ror:8 row_mask:0xf bank_mask:0xc
  v_add_f32_dpp v255, v237, v236 row_ror:8 row_mask:0xf bank_mask:0x3
  v_add_f32_dpp v255, v238, v239 row_ror:8 row_mask:0xf bank_mask:0xc
  ds_write_b128 v4, v[252:255] offset:32768
  v_max3_f32 v11, v252, v253, v24
  v_max3_f32 v24, v254, v255, v11
  v_mul_f32 v11, s52, v24
  v_sub_f32 v10, v8, v11
  v_exp_f32 v10, v10
  v_mov_b32 v8, v11
  v_fma_f32 v240, v252, s52, -v11
  v_fma_f32 v241, v253, s52, -v11
  v_fma_f32 v242, v254, s52, -v11
  v_fma_f32 v243, v255, s52, -v11
  v_exp_f32 v240, v240
  v_exp_f32 v241, v241
  v_exp_f32 v242, v242
  v_exp_f32 v243, v243
  v_fma_f32 v9, v9, v10, v240
  v_add_f32 v11, v241, v242
  v_add_f32 v9, v9, v243
  v_add_f32 v9, v9, v11
  s_waitcnt lgkmcnt(0)
  v_readfirstlane_b32 s55, v30
  v_readfirstlane_b32 s56, v31
  v_or_b32_e64 v30, 1, s20
  s_mov_b64 exec, 1
  ds_write_b32 v29, v30 offset:25888
  s_mov_b64 exec, -1
  v_add_u32 v29, 8, v29
  s_mul_i32 s57, s56, s6
  s_ashr_i32 s57, s57, 5
  s_add_u32 s55, s55, s57
  s_sub_u32 s55, s55, s20
  s_ashr_i32 s55, s55, 4
  s_max_i32 s55, s55, 0
  s_min_i32 s55, s55, 7
  s_lshl_b32 s55, s55, 2
  s_lshr_b32 s55, 1126310160, s55
  s_and_b32 s55, s55, 15
  s_cmp_lg_u32 s56, 0
  s_cselect_b32 s7, s55, 2
  s_add_u32 s6, s6, 1
  s_branch L_kp2
L_kb1:
  ds_read_b128 v[192:195], v3 offset:4160
  ds_read_b128 v[196:199], v3 offset:4176
  ds_read_b128 v[200:203], v3 offset:12480
  ds_read_b128 v[204:207], v3 offset:12496
  ds_read_b128 v[208:211], v3 offset:4416
  ds_read_b128 v[212:215], v3 offset:4432
  ds_read_b128 v[216:219], v3 offset:12736
  ds_read_b128 v[220:223], v3 offset:12752
  s_waitcnt lgkmcnt(4)
  v_pk_add_f32 v[192:193], v[192:193], v[200:201]
  v_pk_add_f32 v[194:195], v[194:195], v[202:203]
  v_pk_add_f32 v[196:197], v[196:197], v[204:205]
  v_pk_add_f32 v[198:199], v[198:199], v[206:207]
  v_cvt_pk_bf16_f32 v16, v192, v193
  v_cvt_pk_bf16_f32 v17, v194, v195
  v_cvt_pk_bf16_f32 v18, v196, v197
  v_cvt_pk_bf16_f32 v19, v198, v199
  s_waitcnt lgkmcnt(0)
  v_pk_add_f32 v[208:209], v[208:209], v[216:217]
  v_pk_add_f32 v[210:211], v[210:211], v[218:219]
  v_pk_add_f32 v[212:213], v[212:213], v[220:221]
  v_pk_add_f32 v[214:215], v[214:215], v[222:223]
  v_cvt_pk_bf16_f32 v20, v208, v209
  v_cvt_pk_bf16_f32 v21, v210, v211
  v_cvt_pk_bf16_f32 v22, v212, v213
  v_cvt_pk_bf16_f32 v23, v214, v215
L_kloop:
  s_cmp_lt_u32 s7, 1
  s_cbranch_scc1 L_tk0
  s_waitcnt vmcnt(12)
  s_cmp_lt_u32 s7, 2
  s_cbranch_scc1 L_tk0
  s_waitcnt vmcnt(8)
  s_cmp_lt_u32 s7, 3
  s_cbranch_scc1 L_tk0
  s_waitcnt vmcnt(7)
  s_cmp_lt_u32 s7, 4
  s_cbranch_scc1 L_tk0
  s_waitcnt vmcnt(5)
L_tk0:
  buffer_load_dwordx4 v[128:131], v1, s[8:11], s54 offen offset:0 nt
  buffer_load_dwordx4 v[132:135], v1, s[8:11], s54 offen offset:128 nt
  buffer_load_dwordx4 v[136:139], v1, s[8:11], s54 offen offset:256 nt
  buffer_load_dwordx4 v[140:143], v1, s[8:11], s54 offen offset:384 nt
  buffer_load_dwordx4 v[144:147], v1, s[8:11], s54 offen offset:512 nt
  buffer_load_dwordx4 v[148:151], v1, s[8:11], s54 offen offset:640 nt
  buffer_load_dwordx4 v[152:155], v1, s[8:11], s54 offen offset:768 nt
  buffer_load_dwordx4 v[156:159], v1, s[8:11], s54 offen offset:896 nt
  s_waitcnt vmcnt(16)
  v_mfma_f32_16x16x32_bf16 v[224:227], v[64:67], v[16:19], 0
  v_mfma_f32_16x16x32_bf16 v[228:231], v[72:75], v[16:19], 0
  v_mfma_f32_16x16x32_bf16 v[232:235], v[80:83], v[16:19], 0
  v_mfma_f32_16x16x32_bf16 v[236:239], v[88:91], v[16:19], 0
  v_mfma_f32_16x16x32_bf16 v[224:227], v[68:71], v[20:23], v[224:227]
  v_mfma_f32_16x16x32_bf16 v[228:231], v[76:79], v[20:23], v[228:231]
  v_mfma_f32_16x16x32_bf16 v[232:235], v[84:87], v[20:23], v[232:235]
  v_mfma_f32_16x16x32_bf16 v[236:239], v[92:95], v[20:23], v[236:239]
  s_add_u32 s54, s54, 0x4000
  s_bitcmp1_b32 s54, 19
  s_cselect_b32 s55, 0x880000, 0
  s_xor_b32 s54, s54, s55
  s_nop 0
  v_add_f32_dpp v252, v225, v224 row_ror:8 row_mask:0xf bank_mask:0x3
  v_add_f32_dpp v252, v226, v227 row_ror:8 row_mask:0xf bank_mask:0xc
  v_add_f32_dpp v253, v229, v228 row_ror:8 row_mask:0xf bank_mask:0x3
  v_add_f32_dpp v253, v230, v231 row_ror:8 row_mask:0xf bank_mask:0xc
  v_add_f32_dpp v254, v233, v232 row_ror:8 row_mask:0xf bank_mask:0x3
  v_add_f32_dpp v254, v234, v235 row_ror:8 row_mask:0xf bank_mask:0xc
  v_add_f32_dpp v255, v237, v236 row_ror:8 row_mask:0xf bank_mask:0x3
  v_add_f32_dpp v255, v238, v239 row_ror:8 row_mask:0xf bank_mask:0xc
  ds_write_b128 v4, v[252:255] offset:0
  v_max3_f32 v11, v252, v253, v24
  v_max3_f32 v24, v254, v255, v11
  v_mul_f32 v11, s52, v24
  v_sub_f32 v10, v8, v11
  v_exp_f32 v10, v10
  v_mov_b32 v8, v11
  v_fma_f32 v240, v252, s52, -v11
  v_fma_f32 v241, v253, s52, -v11
  v_fma_f32 v242, v254, s52, -v11
  v_fma_f32 v243, v255, s52, -v11
  v_exp_f32 v240, v240
  v_exp_f32 v241, v241
  v_exp_f32 v242, v242
  v_exp_f32 v243, v243
  v_fma_f32 v9, v9, v10, v240
  v_add_f32 v11, v241, v242
  v_add_f32 v9, v9, v243
  v_add_f32 v9, v9, v11
  s_cmp_lt_u32 s7, 1
  s_cbranch_scc1 L_tk1
  s_waitcnt vmcnt(12)
  s_cmp_lt_u32 s7, 2
  s_cbranch_scc1 L_tk1
  s_waitcnt vmcnt(8)
  s_cmp_lt_u32 s7, 3
  s_cbranch_scc1 L_tk1
  s_waitcnt vmcnt(7)
  s_cmp_lt_u32 s7, 4
  s_cbranch_scc1 L_tk1
  s_waitcnt vmcnt(5)
L_tk1:
  buffer_load_dwordx4 v[160:163], v1, s[8:11], s54 offen offset:0 nt
  buffer_load_dwordx4 v[164:167], v1, s[8:11], s54 offen offset:128 nt
  buffer_load_dwordx4 v[168:171], v1, s[8:11], s54 offen offset:256 nt
  buffer_load_dwordx4 v[172:175], v1, s[8:11], s54 offen offset:384 nt
  buffer_load_dwordx4 v[176:179], v1, s[8:11], s54 offen offset:512 nt
  buffer_load_dwordx4 v[180:183], v1, s[8:11], s54 offen offset:640 nt
  buffer_load_dwordx4 v[184:187], v1, s[8:11], s54 offen offset:768 nt
  buffer_load_dwordx4 v[188:191], v1, s[8:11], s54 offen offset:896 nt
  s_waitcnt vmcnt(16)
  s_memrealtime s[20:21]
  ds_read_b64 v[30:31], v13 offset:26136
  v_mfma_f32_16x16x32_bf16 v[224:227], v[96:99], v[16:19], 0
  v_mfma_f32_16x16x32_bf16 v[228:231], v[104:107], v[16:19], 0
  v_mfma_f32_16x16x32_bf16 v[232:235], v[112:115], v[16:19], 0
  v_mfma_f32_16x16x32_bf16 v[236:239], v[120:123], v[16:19], 0
  v_mfma_f32_16x16x32_bf16 v[224:227], v[100:103], v[20:23], v[224:227]
  v_mfma_f32_16x16x32_bf16 v[228:231], v[108:111], v[20:23], v[228:231]
  v_mfma_f32_16x16x32_bf16 v[232:235], v[116:119], v[20:23], v[232:235]
  v_mfma_f32_16x16x32_bf16 v[236:239], v[124:127], v[20:23], v[236:239]
  s_add_u32 s54, s54, 0x4000
  s_bitcmp1_b32 s54, 19
  s_cselect_b32 s55, 0x880000, 0
  s_xor_b32 s54, s54, s55
  s_nop 0
  v_add_f32_dpp v252, v225, v224 row_ror:8 row_mask:0xf bank_mask:0x3
  v_add_f32_dpp v252, v226, v227 row_ror:8 row_mask:0xf bank_mask:0xc
  v_add_f32_dpp v253, v229, v228 row_ror:8 row_mask:0xf bank_mask:0x3
  v_add_f32_dpp v253, v230, v231 row_ror:8 row_mask:0xf bank_mask:0xc
  v_add_f32_dpp v254, v233, v232 row_ror:8 row_mask:0xf bank_mask:0x3
  v_add_f32_dpp v254, v234, v235 row_ror:8 row_mask:0xf bank_mask:0xc
  v_add_f32_dpp v255, v237, v236 row_ror:8 row_mask:0xf bank_mask:0x3
  v_add_f32_dpp v255, v238, v239 row_ror:8 row_mask:0xf bank_mask:0xc
  ds_write_b128 v4, v[252:255] offset:32768
  v_max3_f32 v11, v252, v253, v24
  v_max3_f32 v24, v254, v255, v11
  v_mul_f32 v11, s52, v24
  v_sub_f32 v10, v8, v11
  v_exp_f32 v10, v10
  v_mov_b32 v8, v11
  v_fma_f32 v240, v252, s52, -v11
  v_fma_f32 v241, v253, s52, -v11
  v_fma_f32 v242, v254, s52, -v11
  v_fma_f32 v243, v255, s52, -v11
  v_exp_f32 v240, v240
  v_exp_f32 v241, v241
  v_exp_f32 v242, v242
  v_exp_f32 v243, v243
  v_fma_f32 v9, v9, v10, v240
  v_add_f32 v11, v241, v242
  v_add_f32 v9, v9, v243
  v_add_f32 v9, v9, v11
  s_waitcnt lgkmcnt(0)
  v_readfirstlane_b32 s55, v30
  v_readfirstlane_b32 s56, v31
  v_or_b32_e64 v30, 1, s20
  s_mov_b64 exec, 1
  ds_write_b32 v29, v30 offset:25888
  s_mov_b64 exec, -1
  v_add_u32 v29, 8, v29
  s_mul_i32 s57, s56, s6
  s_ashr_i32 s57, s57, 5
  s_add_u32 s55, s55, s57
  s_sub_u32 s55, s55, s20
  s_ashr_i32 s55, s55, 4
  s_max_i32 s55, s55, 0
  s_min_i32 s55, s55, 7
  s_lshl_b32 s55, s55, 2
  s_lshr_b32 s55, 1126310160, s55
  s_and_b32 s55, s55, 15
  s_cmp_lg_u32 s56, 0
  s_cselect_b32 s7, s55, 2
  s_add_u32 s6, s6, 1
L_kp2:
  s_cmp_lt_u32 s7, 1
  s_cbranch_scc1 L_tk2
  s_waitcnt vmcnt(12)
  s_cmp_lt_u32 s7, 2
  s_cbranch_scc1 L_tk2
  s_waitcnt vmcnt(8)
  s_cmp_lt_u32 s7, 3
  s_cbranch_scc1 L_tk2
  s_waitcnt vmcnt(7)
  s_cmp_lt_u32 s7, 4
  s_cbranch_scc1 L_tk2
  s_waitcnt vmcnt(5)
L_tk2:
  s_cmp_eq_u32 s53, 1
  s_cbranch_scc1 L_kv2
  buffer_load_dwordx4 v[64:67], v1, s[8:11], s54 offen offset:0 nt
  buffer_load_dwordx4 v[68:71], v1, s[8:11], s54 offen offset:128 nt
  buffer_load_dwordx4 v[72:75], v1, s[8:11], s54 offen offset:256 nt
  buffer_load_dwordx4 v[76:79], v1, s[8:11], s54 offen offset:384 nt
  buffer_load_dwordx4 v[80:83], v1, s[8:11], s54 offen offset:512 nt
  buffer_load_dwordx4 v[84:87], v1, s[8:11], s54 offen offset:640 nt
  buffer_load_dwordx4 v[88:91], v1, s[8:11], s54 offen offset:768 nt
  buffer_load_dwordx4 v[92:95], v1, s[8:11], s54 offen offset:896 nt
L_kr2:
  s_waitcnt vmcnt(16)
  v_mfma_f32_16x16x32_bf16 v[224:227], v[128:131], v[16:19], 0
  v_mfma_f32_16x16x32_bf16 v[228:231], v[136:139], v[16:19], 0
  v_mfma_f32_16x16x32_bf16 v[232:235], v[144:147], v[16:19], 0
  v_mfma_f32_16x16x32_bf16 v[236:239], v[152:155], v[16:19], 0
  v_mfma_f32_16x16x32_bf16 v[224:227], v[132:135], v[20:23], v[224:227]
  v_mfma_f32_16x16x32_bf16 v[228:231], v[140:143], v[20:23], v[228:231]
  v_mfma_f32_16x16x32_bf16 v[232:235], v[148:151], v[20:23], v[232:235]
  v_mfma_f32_16x16x32_bf16 v[236:239], v[156:159], v[20:23], v[236:239]
  s_add_u32 s54, s54, 0x4000
  s_bitcmp1_b32 s54, 19
  s_cselect_b32 s55, 0x880000, 0
  s_xor_b32 s54, s54, s55
  s_nop 0
  v_add_f32_dpp v252, v225, v224 row_ror:8 row_mask:0xf bank_mask:0x3
  v_add_f32_dpp v252, v226, v227 row_ror:8 row_mask:0xf bank_mask:0xc
  v_add_f32_dpp v253, v229, v228 row_ror:8 row_mask:0xf bank_mask:0x3
  v_add_f32_dpp v253, v230, v231 row_ror:8 row_mask:0xf bank_mask:0xc
  v_add_f32_dpp v254, v233, v232 row_ror:8 row_mask:0xf bank_mask:0x3
  v_add_f32_dpp v254, v234, v235 row_ror:8 row_mask:0xf bank_mask:0xc
  v_add_f32_dpp v255, v237, v236 row_ror:8 row_mask:0xf bank_mask:0x3
  v_add_f32_dpp v255, v238, v239 row_ror:8 row_mask:0xf bank_mask:0xc
  ds_write_b128 v4, v[252:255] offset:1024
  v_max3_f32 v11, v252, v253, v24
  v_max3_f32 v24, v254, v255, v11
  v_mul_f32 v11, s52, v24
  v_sub_f32 v10, v8, v11
  v_exp_f32 v10, v10
  v_mov_b32 v8, v11
  v_fma_f32 v240, v252, s52, -v11
  v_fma_f32 v241, v253, s52, -v11
  v_fma_f32 v242, v254, s52, -v11
  v_fma_f32 v243, v255, s52, -v11
  v_exp_f32 v240, v240
  v_exp_f32 v241, v241
  v_exp_f32 v242, v242
  v_exp_f32 v243, v243
  v_fma_f32 v9, v9, v10, v240
  v_add_f32 v11, v241, v242
  v_add_f32 v9, v9, v243
  v_add_f32 v9, v9, v11
  s_cmp_lt_u32 s7, 1
  s_cbranch_scc1 L_tk3
  s_waitcnt vmcnt(12)
  s_cmp_lt_u32 s7, 2
  s_cbranch_scc1 L_tk3
  s_waitcnt vmcnt(8)
  s_cmp_lt_u32 s7, 3
  s_cbranch_scc1 L_tk3
  s_waitcnt vmcnt(7)
  s_cmp_lt_u32 s7, 4
  s_cbranch_scc1 L_tk3
  s_waitcnt vmcnt(5)
L_tk3:
  s_cmp_eq_u32 s53, 1
  s_cbranch_scc1 L_kv3
  buffer_load_dwordx4 v[96:99], v1, s[8:11], s54 offen offset:0 nt
  buffer_load_dwordx4 v[100:103], v1, s[8:11], s54 offen offset:128 nt
  buffer_load_dwordx4 v[104:107], v1, s[8:11], s54 offen offset:256 nt
  buffer_load_dwordx4 v[108:111], v1, s[8:11], s54 offen offset:384 nt
  buffer_load_dwordx4 v[112:115], v1, s[8:11], s54 offen offset:512 nt
  buffer_load_dwordx4 v[116:119], v1, s[8:11], s54 offen offset:640 nt
  buffer_load_dwordx4 v[120:123], v1, s[8:11], s54 offen offset:768 nt
  buffer_load_dwordx4 v[124:127], v1, s[8:11], s54 offen offset:896 nt
L_kr3:
  s_waitcnt vmcnt(16)
  s_memrealtime s[20:21]
  ds_read_b64 v[30:31], v13 offset:26136
  v_mfma_f32_16x16x32_bf16 v[224:227], v[160:163], v[16:19], 0
  v_mfma_f32_16x16x32_bf16 v[228:231], v[168:171], v[16:19], 0
  v_mfma_f32_16x16x32_bf16 v[232:235], v[176:179], v[16:19], 0
  v_mfma_f32_16x16x32_bf16 v[236:239], v[184:187], v[16:19], 0
  v_mfma_f32_16x16x32_bf16 v[224:227], v[164:167], v[20:23], v[224:227]
  v_mfma_f32_16x16x32_bf16 v[228:231], v[172:175], v[20:23], v[228:231]
  v_mfma_f32_16x16x32_bf16 v[232:235], v[180:183], v[20:23], v[232:235]
  v_mfma_f32_16x16x32_bf16 v[236:239], v[188:191], v[20:23], v[236:239]
  s_add_u32 s54, s54, 0x4000
  s_bitcmp1_b32 s54, 19
  s_cselect_b32 s55, 0x880000, 0
  s_xor_b32 s54, s54, s55
  s_nop 0
  v_add_f32_dpp v252, v225, v224 row_ror:8 row_mask:0xf bank_mask:0x3
  v_add_f32_dpp v252, v226, v227 row_ror:8 row_mask:0xf bank_mask:0xc
  v_add_f32_dpp v253, v229, v228 row_ror:8 row_mask:0xf bank_mask:0x3
  v_add_f32_dpp v253, v230, v231 row_ror:8 row_mask:0xf bank_mask:0xc
  v_add_f32_dpp v254, v233, v232 row_ror:8 row_mask:0xf bank_mask:0x3
  v_add_f32_dpp v254, v234, v235 row_ror:8 row_mask:0xf bank_mask:0xc
  v_add_f32_dpp v255, v237, v236 row_ror:8 row_mask:0xf bank_mask:0x3
  v_add_f32_dpp v255, v238, v239 row_ror:8 row_mask:0xf bank_mask:0xc
  ds_write_b128 v4, v[252:255] offset:33792
  v_max3_f32 v11, v252, v253, v24
  v_max3_f32 v24, v254, v255, v11
  v_mul_f32 v11, s52, v24
  v_sub_f32 v10, v8, v11
  v_exp_f32 v10, v10
  v_mov_b32 v8, v11
  v_fma_f32 v240, v252, s52, -v11
  v_fma_f32 v241, v253, s52, -v11
  v_fma_f32 v242, v254, s52, -v11
  v_fma_f32 v243, v255, s52, -v11
  v_exp_f32 v240, v240
  v_exp_f32 v241, v241
  v_exp_f32 v242, v242
  v_exp_f32 v243, v243
  v_fma_f32 v9, v9, v10, v240
  v_add_f32 v11, v241, v242
  v_add_f32 v9, v9, v243
  v_add_f32 v9, v9, v11
  s_waitcnt lgkmcnt(0)
  v_readfirstlane_b32 s55, v30
  v_readfirstlane_b32 s56, v31
  s_mul_i32 s57, s56, s6
  s_ashr_i32 s57, s57, 5
  s_add_u32 s55, s55, s57
  s_sub_u32 s55, s55, s20
  s_ashr_i32 s55, s55, 4
  s_max_i32 s55, s55, 0
  s_min_i32 s55, s55, 7
  s_lshl_b32 s55, s55, 2
  s_lshr_b32 s55, 1126310160, s55
  s_and_b32 s55, s55, 15
  s_cmp_lg_u32 s56, 0
  s_cselect_b32 s7, s55, 2
  s_add_u32 s6, s6, 1
  v_add_u32 v4, 2048, v4
  s_sub_u32 s53, s53, 1
  s_and_b32 s55, s53, 7
  s_cbranch_scc1 L_kloop
L_kfin:
  v_mov_b32 v11, v8
  s_nop 1
  v_max_f32_dpp v8, v8, v8 row_ror:8 row_mask:0xf bank_mask:0xf
  v_mov_b32 v12, v8
  s_nop 1
  v_permlane32_swap_b32 v8, v12
  v_max_f32 v8, v8, v12
  v_mov_b32 v12, v8
  s_nop 1
  v_permlane16_swap_b32 v8, v12
  v_max_f32 v8, v8, v12
  v_sub_f32 v11, v11, v8
  v_exp_f32 v11, v11
  s_nop 0
  v_mul_f32 v9, v9, v11
  s_nop 1
  v_add_f32_dpp v9, v9, v9 row_ror:8 row_mask:0xf bank_mask:0xf
  v_mov_b32 v12, v9
  s_nop 1
  v_permlane32_swap_b32 v9, v12
  v_add_f32 v9, v9, v12
  v_mov_b32 v12, v9
  s_nop 1
  v_permlane16_swap_b32 v9, v12
  v_add_f32 v9, v9, v12
  ds_write_b64 v5, v[8:9] offset:0
  v_mov_b32 v11, 1
  v_add_u32 v5, 256, v5
  v_mov_b32 v8, 0xf149f2ca
  v_mov_b32 v9, 0
  v_mov_b32 v24, 0xf149f2ca
  s_cmp_lt_u32 s3, 2
  s_cbranch_scc1 L_kf1
  ds_write_b64 v5, v[8:9] offset:0
L_kf1:
  s_mov_b64 exec, 1
  s_waitcnt lgkmcnt(0)
  ds_add_u32 v25, v11 offset:516
  s_mov_b64 exec, -1
  v_add_u32 v25, 12, v25
  s_not_b64 s[32:33], s[60:61]
  s_cmp_ge_u32 s3, 2
  s_cbranch_scc1 L_vr1
  s_cmp_lg_u32 s53, 0
  s_cbranch_scc1 L_kb1
  v_mov_b32 v4, v28
  v_mov_b32 v25, 131072
  s_mov_b32 s53, 16
  s_mov_b32 s5, 4
  s_not_b64 s[32:33], s[60:61]
L_vstart:
L_wk:
  ds_read_b32 v11, v25 offset:516
  s_waitcnt lgkmcnt(0)
  v_readfirstlane_b32 s55, v11
  s_cmp_lt_u32 s55, s5
  s_cbranch_scc1 L_wk
  ds_read_b128 v[192:195], v7 offset:0
  ds_read_b128 v[196:199], v7 offset:16
  ds_read_b128 v[252:255], v4
  v_pk_mul_f32 v[32:33], v[26:27], v[26:27]
  v_pk_mul_f32 v[34:35], v[26:27], v[26:27]
  v_pk_mul_f32 v[36:37], v[26:27], v[26:27]
  v_pk_mul_f32 v[38:39], v[26:27], v[26:27]
  v_pk_mul_f32 v[40:41], v[26:27], v[26:27]
  v_pk_mul_f32 v[42:43], v[26:27], v[26:27]
  v_pk_mul_f32 v[44:45], v[26:27], v[26:27]
  v_pk_mul_f32 v[46:47], v[26:27], v[26:27]
  v_pk_mul_f32 v[48:49], v[26:27], v[26:27]
  v_pk_mul_f32 v[50:51], v[26:27], v[26:27]
  v_pk_mul_f32 v[52:53], v[26:27], v[26:27]
  v_pk_mul_f32 v[54:55], v[26:27], v[26:27]
  v_pk_mul_f32 v[56:57], v[26:27], v[26:27]
  v_pk_mul_f32 v[58:59], v[26:27], v[26:27]
  v_pk_mul_f32 v[60:61], v[26:27], v[26:27]
  v_pk_mul_f32 v[62:63], v[26:27], v[26:27]
  v_add_u32 v25, 12, v25
  v_add_u32 v7, 256, v7
  s_mov_b32 s5, 2
  s_waitcnt lgkmcnt(1)
  v_max3_f32 v8, v192, v194, v196
  v_max_f32 v8, v8, v198
  v_sub_f32 v192, v192, v8
  v_sub_f32 v194, v194, v8
  v_sub_f32 v196, v196, v8
  v_sub_f32 v198, v198, v8
  v_exp_f32 v192, v192
  v_exp_f32 v194, v194
  v_exp_f32 v196, v196
  v_exp_f32 v198, v198
  v_mul_f32 v9, v192, v193
  v_fmac_f32 v9, v194, v195
  v_fmac_f32 v9, v196, v197
  v_fmac_f32 v9, v198, v199
  v_log_f32 v9, v9
  s_nop 0
  v_add_f32 v8, v8, v9
L_vloop:
  s_waitcnt lgkmcnt(0)
  v_fma_f32 v252, v252, s52, -v8
  v_fma_f32 v253, v253, s52, -v8
  v_fma_f32 v254, v254, s52, -v8
  v_fma_f32 v255, v255, s52, -v8
  v_exp_f32 v252, v252
  v_exp_f32 v253, v253
  v_exp_f32 v254, v254
  v_exp_f32 v255, v255
  s_nop 0
  v_cvt_pk_bf16_f32 v248, v252, v253
  v_cvt_pk_bf16_f32 v249, v254, v255
  v_cvt_pk_bf16_f32 v250, v252, v253
  v_cvt_pk_bf16_f32 v251, v254, v255
  ds_read_b128 v[252:255], v4 offset:32768
  v_mov_b32_dpp v248, v248 row_ror:8 row_mask:0xf bank_mask:0xc
  v_mov_b32_dpp v249, v249 row_ror:8 row_mask:0xf bank_mask:0xc
  v_mov_b32_dpp v250, v250 row_ror:8 row_mask:0xf bank_mask:0x3
  v_mov_b32_dpp v251, v251 row_ror:8 row_mask:0xf bank_mask:0x3
  s_cmp_lt_u32 s7, 1
  s_cbranch_scc1 L_tv0
  s_waitcnt vmcnt(12)
  s_cmp_lt_u32 s7, 2
  s_cbranch_scc1 L_tv0
  s_waitcnt vmcnt(8)
  s_cmp_lt_u32 s7, 3
  s_cbranch_scc1 L_tv0
  s_waitcnt vmcnt(7)
  s_cmp_lt_u32 s7, 4
  s_cbranch_scc1 L_tv0
  s_waitcnt vmcnt(5)
L_tv0:
  buffer_load_dwordx4 v[128:131], v2, s[12:15], s54 offen offset:0 nt
  buffer_load_dwordx4 v[132:135], v2, s[12:15], s54 offen offset:256 nt
  buffer_load_dwordx4 v[136:139], v2, s[12:15], s54 offen offset:512 nt
  buffer_load_dwordx4 v[140:143], v2, s[12:15], s54 offen offset:768 nt
  buffer_load_dwordx4 v[144:147], v2, s[12:15], s54 offen offset:1024 nt
  buffer_load_dwordx4 v[148:151], v2, s[12:15], s54 offen offset:1280 nt
  buffer_load_dwordx4 v[152:155], v2, s[12:15], s54 offen offset:1536 nt
  buffer_load_dwordx4 v[156:159], v2, s[12:15], s54 offen offset:1792 nt
  s_add_u32 s54, s54, 0x4000
  s_bitcmp1_b32 s54, 19
  s_cselect_b32 s55, 0x880000, 0
  s_xor_b32 s54, s54, s55
  s_waitcnt vmcnt(16)
  v_perm_b32 v240, v68, v64, s50
  v_perm_b32 v241, v76, v72, s50
  v_perm_b32 v242, v84, v80, s50
  v_perm_b32 v243, v92, v88, s50
  v_perm_b32 v244, v68, v64, s51
  v_perm_b32 v245, v76, v72, s51
  v_perm_b32 v246, v84, v80, s51
  v_perm_b32 v247, v92, v88, s51
  v_mfma_f32_16x16x32_bf16 v[32:35], v[240:243], v[248:251], v[32:35]
  v_perm_b32 v240, v69, v65, s50
  v_perm_b32 v241, v77, v73, s50
  v_perm_b32 v242, v85, v81, s50
  v_perm_b32 v243, v93, v89, s50
  v_mfma_f32_16x16x32_bf16 v[36:39], v[244:247], v[248:251], v[36:39]
  v_perm_b32 v244, v69, v65, s51
  v_perm_b32 v245, v77, v73, s51
  v_perm_b32 v246, v85, v81, s51
  v_perm_b32 v247, v93, v89, s51
  v_mfma_f32_16x16x32_bf16 v[40:43], v[240:243], v[248:251], v[40:43]
  v_perm_b32 v240, v70, v66, s50
  v_perm_b32 v241, v78, v74, s50
  v_perm_b32 v242, v86, v82, s50
  v_perm_b32 v243, v94, v90, s50
  v_mfma_f32_16x16x32_bf16 v[44:47], v[244:247], v[248:251], v[44:47]
  v_perm_b32 v244, v70, v66, s51
  v_perm_b32 v245, v78, v74, s51
  v_perm_b32 v246, v86, v82, s51
  v_perm_b32 v247, v94, v90, s51
  v_mfma_f32_16x16x32_bf16 v[48:51], v[240:243], v[248:251], v[48:51]
  v_perm_b32 v240, v71, v67, s50
  v_perm_b32 v241, v79, v75, s50
  v_perm_b32 v242, v87, v83, s50
  v_perm_b32 v243, v95, v91, s50
  v_mfma_f32_16x16x32_bf16 v[52:55], v[244:247], v[248:251], v[52:55]
  v_perm_b32 v244, v71, v67, s51
  v_perm_b32 v245, v79, v75, s51
  v_perm_b32 v246, v87, v83, s51
  v_perm_b32 v247, v95, v91, s51
  v_mfma_f32_16x16x32_bf16 v[56:59], v[240:243], v[248:251], v[56:59]
  s_nop 1
  v_mfma_f32_16x16x32_bf16 v[60:63], v[244:247], v[248:251], v[60:63]
  s_waitcnt lgkmcnt(0)
  v_fma_f32 v252, v252, s52, -v8
  v_fma_f32 v253, v253, s52, -v8
  v_fma_f32 v254, v254, s52, -v8
  v_fma_f32 v255, v255, s52, -v8
  v_exp_f32 v252, v252
  v_exp_f32 v253, v253
  v_exp_f32 v254, v254
  v_exp_f32 v255, v255
  s_nop 0
  v_cvt_pk_bf16_f32 v248, v252, v253
  v_cvt_pk_bf16_f32 v249, v254, v255
  v_cvt_pk_bf16_f32 v250, v252, v253
  v_cvt_pk_bf16_f32 v251, v254, v255
  ds_read_b128 v[252:255], v4 offset:1024
  v_mov_b32_dpp v248, v248 row_ror:8 row_mask:0xf bank_mask:0xc
  v_mov_b32_dpp v249, v249 row_ror:8 row_mask:0xf bank_mask:0xc
  v_mov_b32_dpp v250, v250 row_ror:8 row_mask:0xf bank_mask:0x3
  v_mov_b32_dpp v251, v251 row_ror:8 row_mask:0xf bank_mask:0x3
  s_cmp_lt_u32 s7, 1
  s_cbranch_scc1 L_tv1
  s_waitcnt vmcnt(12)
  s_cmp_lt_u32 s7, 2
  s_cbranch_scc1 L_tv1
  s_waitcnt vmcnt(8)
  s_cmp_lt_u32 s7, 3
  s_cbranch_scc1 L_tv1
  s_waitcnt vmcnt(7)
  s_cmp_lt_u32 s7, 4
  s_cbranch_scc1 L_tv1
  s_waitcnt vmcnt(5)
L_tv1:
  buffer_load_dwordx4 v[160:163], v2, s[12:15], s54 offen offset:0 nt
  buffer_load_dwordx4 v[164:167], v2, s[12:15], s54 offen offset:256 nt
  buffer_load_dwordx4 v[168:171], v2, s[12:15], s54 offen offset:512 nt
  buffer_load_dwordx4 v[172:175], v2, s[12:15], s54 offen offset:768 nt
  buffer_load_dwordx4 v[176:179], v2, s[12:15], s54 offen offset:1024 nt
  buffer_load_dwordx4 v[180:183], v2, s[12:15], s54 offen offset:1280 nt
  buffer_load_dwordx4 v[184:187], v2, s[12:15], s54 offen offset:1536 nt
  buffer_load_dwordx4 v[188:191], v2, s[12:15], s54 offen offset:1792 nt
  s_add_u32 s54, s54, 0x4000
  s_bitcmp1_b32 s54, 19
  s_cselect_b32 s55, 0x880000, 0
  s_xor_b32 s54, s54, s55
  s_waitcnt vmcnt(16)
  s_memrealtime s[20:21]
  ds_read_b64 v[30:31], v13 offset:26136
  v_perm_b32 v240, v100, v96, s50
  v_perm_b32 v241, v108, v104, s50
  v_perm_b32 v242, v116, v112, s50
  v_perm_b32 v243, v124, v120, s50
  v_perm_b32 v244, v100, v96, s51
  v_perm_b32 v245, v108, v104, s51
  v_perm_b32 v246, v116, v112, s51
  v_perm_b32 v247, v124, v120, s51
  v_mfma_f32_16x16x32_bf16 v[32:35], v[240:243], v[248:251], v[32:35]
  v_perm_b32 v240, v101, v97, s50
  v_perm_b32 v241, v109, v105, s50
  v_perm_b32 v242, v117, v113, s50
  v_perm_b32 v243, v125, v121, s50
  v_mfma_f32_16x16x32_bf16 v[36:39], v[244:247], v[248:251], v[36:39]
  v_perm_b32 v244, v101, v97, s51
  v_perm_b32 v245, v109, v105, s51
  v_perm_b32 v246, v117, v113, s51
  v_perm_b32 v247, v125, v121, s51
  v_mfma_f32_16x16x32_bf16 v[40:43], v[240:243], v[248:251], v[40:43]
  v_perm_b32 v240, v102, v98, s50
  v_perm_b32 v241, v110, v106, s50
  v_perm_b32 v242, v118, v114, s50
  v_perm_b32 v243, v126, v122, s50
  v_mfma_f32_16x16x32_bf16 v[44:47], v[244:247], v[248:251], v[44:47]
  v_perm_b32 v244, v102, v98, s51
  v_perm_b32 v245, v110, v106, s51
  v_perm_b32 v246, v118, v114, s51
  v_perm_b32 v247, v126, v122, s51
  v_mfma_f32_16x16x32_bf16 v[48:51], v[240:243], v[248:251], v[48:51]
  v_perm_b32 v240, v103, v99, s50
  v_perm_b32 v241, v111, v107, s50
  v_perm_b32 v242, v119, v115, s50
  v_perm_b32 v243, v127, v123, s50
  v_mfma_f32_16x16x32_bf16 v[52:55], v[244:247], v[248:251], v[52:55]
  v_perm_b32 v244, v103, v99, s51
  v_perm_b32 v245, v111, v107, s51
  v_perm_b32 v246, v119, v115, s51
  v_perm_b32 v247, v127, v123, s51
  v_mfma_f32_16x16x32_bf16 v[56:59], v[240:243], v[248:251], v[56:59]
  s_nop 1
  v_mfma_f32_16x16x32_bf16 v[60:63], v[244:247], v[248:251], v[60:63]
  s_waitcnt lgkmcnt(0)
  v_readfirstlane_b32 s55, v30
  v_readfirstlane_b32 s56, v31
  v_or_b32_e64 v30, 1, s20
  s_mov_b64 exec, 1
  ds_write_b32 v29, v30 offset:25888
  s_mov_b64 exec, -1
  v_add_u32 v29, 8, v29
  s_mul_i32 s57, s56, s6
  s_ashr_i32 s57, s57, 5
  s_add_u32 s55, s55, s57
  s_sub_u32 s55, s55, s20
  s_ashr_i32 s55, s55, 4
  s_max_i32 s55, s55, 0
  s_min_i32 s55, s55, 7
  s_lshl_b32 s55, s55, 2
  s_lshr_b32 s55, 1126310160, s55
  s_and_b32 s55, s55, 15
  s_cmp_lg_u32 s56, 0
  s_cselect_b32 s7, s55, 2
  s_cmp_ge_i32 s6, 21
  s_cselect_b32 s55, 2, 15
  s_min_u32 s7, s7, s55
  s_add_u32 s6, s6, 1
  s_waitcnt lgkmcnt(0)
  v_fma_f32 v252, v252, s52, -v8
  v_fma_f32 v253, v253, s52, -v8
  v_fma_f32 v254, v254, s52, -v8
  v_fma_f32 v255, v255, s52, -v8
  v_exp_f32 v252, v252
  v_exp_f32 v253, v253
  v_exp_f32 v254, v254
  v_exp_f32 v255, v255
  s_nop 0
  v_cvt_pk_bf16_f32 v248, v252, v253
  v_cvt_pk_bf16_f32 v249, v254, v255
  v_cvt_pk_bf16_f32 v250, v252, v253
  v_cvt_pk_bf16_f32 v251, v254, v255
  ds_read_b128 v[252:255], v4 offset:33792
  v_mov_b32_dpp v248, v248 row_ror:8 row_mask:0xf bank_mask:0xc
  v_mov_b32_dpp v249, v249 row_ror:8 row_mask:0xf bank_mask:0xc
  v_mov_b32_dpp v250, v250 row_ror:8 row_mask:0xf bank_mask:0x3
  v_mov_b32_dpp v251, v251 row_ror:8 row_mask:0xf bank_mask:0x3
  s_cmp_eq_u32 s53, 1
  s_cbranch_scc1 L_vl2
  s_cmp_lt_u32 s7, 1
  s_cbranch_scc1 L_tv2
  s_waitcnt vmcnt(12)
  s_cmp_lt_u32 s7, 2
  s_cbranch_scc1 L_tv2
  s_waitcnt vmcnt(8)
  s_cmp_lt_u32 s7, 3
  s_cbranch_scc1 L_tv2
  s_waitcnt vmcnt(7)
  s_cmp_lt_u32 s7, 4
  s_cbranch_scc1 L_tv2
  s_waitcnt vmcnt(5)
L_tv2:
  buffer_load_dwordx4 v[64:67], v2, s[12:15], s54 offen offset:0 nt
  buffer_load_dwordx4 v[68:71], v2, s[12:15], s54 offen offset:256 nt
  buffer_load_dwordx4 v[72:75], v2, s[12:15], s54 offen offset:512 nt
  buffer_load_dwordx4 v[76:79], v2, s[12:15], s54 offen offset:768 nt
  buffer_load_dwordx4 v[80:83], v2, s[12:15], s54 offen offset:1024 nt
  buffer_load_dwordx4 v[84:87], v2, s[12:15], s54 offen offset:1280 nt
  buffer_load_dwordx4 v[88:91], v2, s[12:15], s54 offen offset:1536 nt
  buffer_load_dwordx4 v[92:95], v2, s[12:15], s54 offen offset:1792 nt
  s_add_u32 s54, s54, 0x4000
  s_bitcmp1_b32 s54, 19
  s_cselect_b32 s55, 0x880000, 0
  s_xor_b32 s54, s54, s55
  s_waitcnt vmcnt(16)
  s_branch L_vc2
L_vl2:
  s_waitcnt vmcnt(8)
L_vc2:
  v_perm_b32 v240, v132, v128, s50
  v_perm_b32 v241, v140, v136, s50
  v_perm_b32 v242, v148, v144, s50
  v_perm_b32 v243, v156, v152, s50
  v_perm_b32 v244, v132, v128, s51
  v_perm_b32 v245, v140, v136, s51
  v_perm_b32 v246, v148, v144, s51
  v_perm_b32 v247, v156, v152, s51
  v_mfma_f32_16x16x32_bf16 v[32:35], v[240:243], v[248:251], v[32:35]
  v_perm_b32 v240, v133, v129, s50
  v_perm_b32 v241, v141, v137, s50
  v_perm_b32 v242, v149, v145, s50
  v_perm_b32 v243, v157, v153, s50
  v_mfma_f32_16x16x32_bf16 v[36:39], v[244:247], v[248:251], v[36:39]
  v_perm_b32 v244, v133, v129, s51
  v_perm_b32 v245, v141, v137, s51
  v_perm_b32 v246, v149, v145, s51
  v_perm_b32 v247, v157, v153, s51
  v_mfma_f32_16x16x32_bf16 v[40:43], v[240:243], v[248:251], v[40:43]
  v_perm_b32 v240, v134, v130, s50
  v_perm_b32 v241, v142, v138, s50
  v_perm_b32 v242, v150, v146, s50
  v_perm_b32 v243, v158, v154, s50
  v_mfma_f32_16x16x32_bf16 v[44:47], v[244:247], v[248:251], v[44:47]
  v_perm_b32 v244, v134, v130, s51
  v_perm_b32 v245, v142, v138, s51
  v_perm_b32 v246, v150, v146, s51
  v_perm_b32 v247, v158, v154, s51
  v_mfma_f32_16x16x32_bf16 v[48:51], v[240:243], v[248:251], v[48:51]
  v_perm_b32 v240, v135, v131, s50
  v_perm_b32 v241, v143, v139, s50
  v_perm_b32 v242, v151, v147, s50
  v_perm_b32 v243, v159, v155, s50
  v_mfma_f32_16x16x32_bf16 v[52:55], v[244:247], v[248:251], v[52:55]
  v_perm_b32 v244, v135, v131, s51
  v_perm_b32 v245, v143, v139, s51
  v_perm_b32 v246, v151, v147, s51
  v_perm_b32 v247, v159, v155, s51
  v_mfma_f32_16x16x32_bf16 v[56:59], v[240:243], v[248:251], v[56:59]
  s_nop 1
  v_mfma_f32_16x16x32_bf16 v[60:63], v[244:247], v[248:251], v[60:63]
  s_waitcnt lgkmcnt(0)
  v_fma_f32 v252, v252, s52, -v8
  v_fma_f32 v253, v253, s52, -v8
  v_fma_f32 v254, v254, s52, -v8
  v_fma_f32 v255, v255, s52, -v8
  v_exp_f32 v252, v252
  v_exp_f32 v253, v253
  v_exp_f32 v254, v254
  v_exp_f32 v255, v255
  v_add_u32 v4, 2048, v4
  v_cvt_pk_bf16_f32 v248, v252, v253
  v_cvt_pk_bf16_f32 v249, v254, v255
  v_cvt_pk_bf16_f32 v250, v252, v253
  v_cvt_pk_bf16_f32 v251, v254, v255
  ds_read_b128 v[252:255], v4 offset:0
  v_mov_b32_dpp v248, v248 row_ror:8 row_mask:0xf bank_mask:0xc
  v_mov_b32_dpp v249, v249 row_ror:8 row_mask:0xf bank_mask:0xc
  v_mov_b32_dpp v250, v250 row_ror:8 row_mask:0xf bank_mask:0x3
  v_mov_b32_dpp v251, v251 row_ror:8 row_mask:0xf bank_mask:0x3
  s_cmp_lg_u32 s53, 1
  s_cbranch_scc0 L_vr1
  s_cmp_lt_u32 s7, 1
  s_cbranch_scc1 L_tv3
  s_waitcnt vmcnt(12)
  s_cmp_lt_u32 s7, 2
  s_cbranch_scc1 L_tv3
  s_waitcnt vmcnt(8)
  s_cmp_lt_u32 s7, 3
  s_cbranch_scc1 L_tv3
  s_waitcnt vmcnt(7)
  s_cmp_lt_u32 s7, 4
  s_cbranch_scc1 L_tv3
  s_waitcnt vmcnt(5)
L_tv3:
  buffer_load_dwordx4 v[96:99], v2, s[12:15], s54 offen offset:0 nt
  buffer_load_dwordx4 v[100:103], v2, s[12:15], s54 offen offset:256 nt
  buffer_load_dwordx4 v[104:107], v2, s[12:15], s54 offen offset:512 nt
  buffer_load_dwordx4 v[108:111], v2, s[12:15], s54 offen offset:768 nt
  buffer_load_dwordx4 v[112:115], v2, s[12:15], s54 offen offset:1024 nt
  buffer_load_dwordx4 v[116:119], v2, s[12:15], s54 offen offset:1280 nt
  buffer_load_dwordx4 v[120:123], v2, s[12:15], s54 offen offset:1536 nt
  buffer_load_dwordx4 v[124:127], v2, s[12:15], s54 offen offset:1792 nt
  s_add_u32 s54, s54, 0x4000
  s_bitcmp1_b32 s54, 19
  s_cselect_b32 s55, 0x880000, 0
  s_xor_b32 s54, s54, s55
  s_waitcnt vmcnt(16)
  s_memrealtime s[20:21]
  ds_read_b64 v[30:31], v13 offset:26136
  s_cmp_eq_u32 s53, 9
  s_cbranch_scc1 L_vr1
  v_perm_b32 v240, v164, v160, s50
  v_perm_b32 v241, v172, v168, s50
  v_perm_b32 v242, v180, v176, s50
  v_perm_b32 v243, v188, v184, s50
  v_perm_b32 v244, v164, v160, s51
  v_perm_b32 v245, v172, v168, s51
  v_perm_b32 v246, v180, v176, s51
  v_perm_b32 v247, v188, v184, s51
  v_mfma_f32_16x16x32_bf16 v[32:35], v[240:243], v[248:251], v[32:35]
  v_perm_b32 v240, v165, v161, s50
  v_perm_b32 v241, v173, v169, s50
  v_perm_b32 v242, v181, v177, s50
  v_perm_b32 v243, v189, v185, s50
  v_mfma_f32_16x16x32_bf16 v[36:39], v[244:247], v[248:251], v[36:39]
  v_perm_b32 v244, v165, v161, s51
  v_perm_b32 v245, v173, v169, s51
  v_perm_b32 v246, v181, v177, s51
  v_perm_b32 v247, v189, v185, s51
  v_mfma_f32_16x16x32_bf16 v[40:43], v[240:243], v[248:251], v[40:43]
  v_perm_b32 v240, v166, v162, s50
  v_perm_b32 v241, v174, v170, s50
  v_perm_b32 v242, v182, v178, s50
  v_perm_b32 v243, v190, v186, s50
  v_mfma_f32_16x16x32_bf16 v[44:47], v[244:247], v[248:251], v[44:47]
  v_perm_b32 v244, v166, v162, s51
  v_perm_b32 v245, v174, v170, s51
  v_perm_b32 v246, v182, v178, s51
  v_perm_b32 v247, v190, v186, s51
  v_mfma_f32_16x16x32_bf16 v[48:51], v[240:243], v[248:251], v[48:51]
  v_perm_b32 v240, v167, v163, s50
  v_perm_b32 v241, v175, v171, s50
  v_perm_b32 v242, v183, v179, s50
  v_perm_b32 v243, v191, v187, s50
  v_mfma_f32_16x16x32_bf16 v[52:55], v[244:247], v[248:251], v[52:55]
  v_perm_b32 v244, v167, v163, s51
  v_perm_b32 v245, v175, v171, s51
  v_perm_b32 v246, v183, v179, s51
  v_perm_b32 v247, v191, v187, s51
  v_mfma_f32_16x16x32_bf16 v[56:59], v[240:243], v[248:251], v[56:59]
  s_nop 1
  v_mfma_f32_16x16x32_bf16 v[60:63], v[244:247], v[248:251], v[60:63]
  s_waitcnt lgkmcnt(0)
  v_readfirstlane_b32 s55, v30
  v_readfirstlane_b32 s56, v31
  s_mul_i32 s57, s56, s6
  s_ashr_i32 s57, s57, 5
  s_add_u32 s55, s55, s57
  s_sub_u32 s55, s55, s20
  s_ashr_i32 s55, s55, 4
  s_max_i32 s55, s55, 0
  s_min_i32 s55, s55, 7
  s_lshl_b32 s55, s55, 2
  s_lshr_b32 s55, 1126310160, s55
  s_and_b32 s55, s55, 15
  s_cmp_lg_u32 s56, 0
  s_cselect_b32 s7, s55, 2
  s_cmp_ge_i32 s6, 21
  s_cselect_b32 s55, 2, 15
  s_min_u32 s7, s7, s55
  s_add_u32 s6, s6, 1
  s_sub_u32 s53, s53, 1
  s_branch L_vloop
L_vr1:
  s_waitcnt vmcnt(22)
  s_cbranch_scc1 L_ww0
  s_waitcnt vmcnt(6)
L_ww0:
  v_perm_b32 v192, v164, v160, s50
  v_perm_b32 v196, v164, v160, s51
  v_perm_b32 v200, v165, v161, s50
  v_perm_b32 v204, v165, v161, s51
  v_perm_b32 v208, v166, v162, s50
  v_perm_b32 v212, v166, v162, s51
  v_perm_b32 v216, v167, v163, s50
  v_perm_b32 v220, v167, v163, s51
  s_waitcnt vmcnt(20)
  s_cbranch_scc1 L_ww1
  s_waitcnt vmcnt(4)
L_ww1:
  v_perm_b32 v193, v172, v168, s50
  v_perm_b32 v197, v172, v168, s51
  v_perm_b32 v201, v173, v169, s50
  v_perm_b32 v205, v173, v169, s51
  v_perm_b32 v209, v174, v170, s50
  v_perm_b32 v213, v174, v170, s51
  v_perm_b32 v217, v175, v171, s50
  v_perm_b32 v221, v175, v171, s51
  s_waitcnt vmcnt(18)
  s_cbranch_scc1 L_ww2
  s_waitcnt vmcnt(2)
L_ww2:
  v_perm_b32 v194, v180, v176, s50
  v_perm_b32 v198, v180, v176, s51
  v_perm_b32 v202, v181, v177, s50
  v_perm_b32 v206, v181, v177, s51
  v_perm_b32 v210, v182, v178, s50
  v_perm_b32 v214, v182, v178, s51
  v_perm_b32 v218, v183, v179, s50
  v_perm_b32 v222, v183, v179, s51
  s_waitcnt vmcnt(16)
  s_cbranch_scc1 L_ww3
  s_waitcnt vmcnt(0)
L_ww3:
  v_perm_b32 v195, v188, v184, s50
  v_perm_b32 v199, v188, v184, s51
  v_perm_b32 v203, v189, v185, s50
  v_mfma_f32_16x16x32_bf16 v[32:35], v[192:195], v[248:251], v[32:35]
  v_perm_b32 v207, v189, v185, s51
  v_mfma_f32_16x16x32_bf16 v[36:39], v[196:199], v[248:251], v[36:39]
  v_perm_b32 v211, v190, v186, s50
  v_mfma_f32_16x16x32_bf16 v[40:43], v[200:203], v[248:251], v[40:43]
  v_perm_b32 v215, v190, v186, s51
  v_mfma_f32_16x16x32_bf16 v[44:47], v[204:207], v[248:251], v[44:47]
  v_perm_b32 v219, v191, v187, s50
  v_mfma_f32_16x16x32_bf16 v[48:51], v[208:211], v[248:251], v[48:51]
  v_perm_b32 v223, v191, v187, s51
  v_mfma_f32_16x16x32_bf16 v[52:55], v[212:215], v[248:251], v[52:55]
  v_cvt_pk_bf16_f32 v224, v32, v36
  v_cvt_pk_bf16_f32 v228, v33, v37
  v_mfma_f32_16x16x32_bf16 v[56:59], v[216:219], v[248:251], v[56:59]
  v_cvt_pk_bf16_f32 v232, v34, v38
  v_cvt_pk_bf16_f32 v236, v35, v39
  v_mfma_f32_16x16x32_bf16 v[60:63], v[220:223], v[248:251], v[60:63]
  v_cvt_pk_bf16_f32 v225, v40, v44
  v_cvt_pk_bf16_f32 v229, v41, v45
  v_cvt_pk_bf16_f32 v233, v42, v46
  v_cvt_pk_bf16_f32 v237, v43, v47
  v_cvt_pk_bf16_f32 v226, v48, v52
  v_cvt_pk_bf16_f32 v230, v49, v53
  v_cvt_pk_bf16_f32 v234, v50, v54
  v_cvt_pk_bf16_f32 v238, v51, v55
  s_mov_b64 exec, s[32:33]
  v_cvt_pk_bf16_f32 v227, v56, v60
  ds_write_b128 v6, v[224:227] offset:0
  v_cvt_pk_bf16_f32 v231, v57, v61
  ds_write_b128 v6, v[228:231] offset:16
  v_cvt_pk_bf16_f32 v235, v58, v62
  ds_write_b128 v6, v[232:235] offset:32
  v_cvt_pk_bf16_f32 v239, v59, v63
  ds_write_b128 v6, v[236:239] offset:48
  s_mov_b64 exec, -1
  s_cbranch_scc1 L_vnext
  s_waitcnt lgkmcnt(0)
  s_barrier
L_sfin:
  s_endpgm
L_vnext:
  s_cmp_ge_u32 s3, 2
  s_cbranch_scc1 L_wo
  s_mov_b32 s53, 8
  v_mov_b32 v11, 1
  s_waitcnt lgkmcnt(0)
  s_mov_b64 exec, 1
  ds_add_u32 v13, v11 offset:524
  s_mov_b64 exec, -1
  v_add_u32 v6, 4352, v6
  s_waitcnt lgkmcnt(0)
  v_readfirstlane_b32 s55, v30
  v_readfirstlane_b32 s56, v31
  s_mul_i32 s57, s56, s6
  s_ashr_i32 s57, s57, 5
  s_add_u32 s55, s55, s57
  s_sub_u32 s55, s55, s20
  s_ashr_i32 s55, s55, 4
  s_max_i32 s55, s55, 0
  s_min_i32 s55, s55, 7
  s_lshl_b32 s55, s55, 2
  s_lshr_b32 s55, 1126310160, s55
  s_and_b32 s55, s55, 15
  s_cmp_lg_u32 s56, 0
  s_cselect_b32 s7, s55, 2
  s_add_u32 s6, s6, 1
  s_branch L_vstart
L_kv2:
  buffer_load_dwordx4 v[64:67], v2, s[12:15], s54 offen offset:0 nt
  buffer_load_dwordx4 v[68:71], v2, s[12:15], s54 offen offset:256 nt
  buffer_load_dwordx4 v[72:75], v2, s[12:15], s54 offen offset:512 nt
  buffer_load_dwordx4 v[76:79], v2, s[12:15], s54 offen offset:768 nt
  buffer_load_dwordx4 v[80:83], v2, s[12:15], s54 offen offset:1024 nt
  buffer_load_dwordx4 v[84:87], v2, s[12:15], s54 offen offset:1280 nt
  buffer_load_dwordx4 v[88:91], v2, s[12:15], s54 offen offset:1536 nt
  buffer_load_dwordx4 v[92:95], v2, s[12:15], s54 offen offset:1792 nt
  s_branch L_kr2
L_kv3:
  buffer_load_dwordx4 v[96:99], v2, s[12:15], s54 offen offset:0 nt
  buffer_load_dwordx4 v[100:103], v2, s[12:15], s54 offen offset:256 nt
  buffer_load_dwordx4 v[104:107], v2, s[12:15], s54 offen offset:512 nt
  buffer_load_dwordx4 v[108:111], v2, s[12:15], s54 offen offset:768 nt
  buffer_load_dwordx4 v[112:115], v2, s[12:15], s54 offen offset:1024 nt
  buffer_load_dwordx4 v[116:119], v2, s[12:15], s54 offen offset:1280 nt
  buffer_load_dwordx4 v[120:123], v2, s[12:15], s54 offen offset:1536 nt
  buffer_load_dwordx4 v[124:127], v2, s[12:15], s54 offen offset:1792 nt
  s_branch L_kr3
L_wo:
  s_setprio 0
  v_and_b32 v235, 15, v0
  v_lshrrev_b32 v236, 4, v0
  v_mov_b32 v237, 0
  v_mov_b32 v238, 131072
  s_sub_u32 s58, s3, 2
  v_lshrrev_b32 v232, 5, v0
  v_mul_u32_u24 v232, 18432, v232
  v_and_b32 v233, 1, v236
  v_mul_u32_u24 v233, 4608, v233
  v_mul_u32_u24 v234, 12, v235
  v_add3_u32 v232, v232, v233, v234
  s_mul_i32 s55, s58, 192
  v_add_u32 v1, s55, v232
  s_mul_i32 s55, s48, 294912
  s_add_u32 s24, s40, s55
  s_addc_u32 s25, s41, 0
  s_mov_b32 s26, 294912
  s_lshr_b32 s55, s48, 1
  s_xor_b32 s55, s55, s48
  s_and_b32 s55, s55, 4
  s_mul_i32 s55, s55, 3
  s_xor_b32 s48, s48, s55
  s_mov_b32 s27, 0x00020000
  s_mul_i32 s55, s49, 200704
  s_add_u32 s28, s46, s55
  s_addc_u32 s29, s47, 0
  s_mov_b32 s30, 200704
  s_mov_b32 s31, 0x00020000
  s_mov_b32 s8, s42
  s_mov_b32 s9, s43
  s_mov_b32 s10, 147456
  s_mov_b32 s11, 0x00020000
  s_mov_b32 s12, s44
  s_mov_b32 s13, s45
  s_mov_b32 s14, 256
  s_mov_b32 s15, 0x00020000
  v_bfe_u32 v232, v235, 1, 1
  v_lshrrev_b32 v233, 2, v235
  v_lshl_add_u32 v232, v232, 2, v233
  v_mul_u32_u24 v232, 544, v232
  v_lshl_add_u32 v232, v236, 5, v232
  v_and_b32 v233, 1, v235
  v_lshl_add_u32 v232, v233, 4, v232
  v_add_u32 v5, 131616, v232
  v_mul_u32_u24 v232, 24576, v236
  v_lshlrev_b32 v233, 4, v235
  s_lshl_b32 s55, s58, 12
  s_lshl_b32 s56, s48, 8
  s_add_u32 s56, s56, s55
  v_add3_u32 v6, v232, v233, s56
  s_lshr_b32 s56, s48, 1
  s_mul_i32 s56, s56, 24576
  s_add_u32 s55, s55, s56
  s_and_b32 s56, s48, 1
  s_lshl_b32 s56, s56, 7
  s_add_u32 s55, s55, s56
  v_lshrrev_b32 v232, 3, v0
  v_lshlrev_b32 v232, 8, v232
  v_and_b32 v233, 7, v0
  v_lshlrev_b32 v233, 4, v233
  v_add3_u32 v7, v232, v233, s55
  s_add_u32 s16, s46, 0x400000
  s_addc_u32 s17, s47, 0
  s_mov_b32 s18, 0x40000
  s_mov_b32 s19, 0x00020000
  s_cmp_eq_u32 s3, 7
  s_mov_b32 s22, 32
  s_cselect_b32 s22, s22, 0x1000
  s_mov_b32 s23, 0
  s_lshr_b32 s55, s2, 5
  s_lshl_b32 s55, s55, 3
  s_and_b32 s56, s2, 7
  s_add_u32 s55, s55, s56
  s_lshl_b32 s4, s55, 4
  s_add_u32 s4, s4, 2304
  s_lshl_b32 s55, s2, 3
  s_add_u32 s55, s55, s3
  s_cmp_lg_u32 s55, 7
  s_cbranch_scc1 L_notag
  s_memrealtime s[56:57]
  s_waitcnt lgkmcnt(0)
  s_or_b32 s56, s56, 1
  v_mov_b32 v233, s56
  s_mov_b64 exec, 1
  buffer_store_dword v233, v237, s[12:15], 0 offen sc1
  s_mov_b64 exec, -1
L_notag:
L_ws:
  ds_read_b32 v232, v238 offset:516
  s_waitcnt lgkmcnt(0)
  v_readfirstlane_b32 s55, v232
  s_cmp_ge_u32 s55, 2
  s_cbranch_scc1 L_ws_d
  s_sleep 8
  s_branch L_ws
L_ws_d:
  s_mov_b32 s55, 0
  buffer_load_dwordx3 v[200:202], v1, s[24:27], s55 offen offset:0
  buffer_load_dwordx3 v[204:206], v1, s[24:27], s55 offen offset:1152
  s_call_b64 s[20:21], L_agent
  s_waitcnt vmcnt(0)
  buffer_load_dwordx3 v[208:210], v1, s[24:27], s55 offen offset:2304
  buffer_load_dwordx3 v[212:214], v1, s[24:27], s55 offen offset:3456
  s_call_b64 s[20:21], L_agent
  s_waitcnt vmcnt(0)
  s_mov_b32 s55, 9216
  buffer_load_dwordx3 v[216:218], v1, s[24:27], s55 offen offset:0
  buffer_load_dwordx3 v[220:222], v1, s[24:27], s55 offen offset:1152
  s_call_b64 s[20:21], L_agent
  s_waitcnt vmcnt(0)
  buffer_load_dwordx3 v[224:226], v1, s[24:27], s55 offen offset:2304
  buffer_load_dwordx3 v[228:230], v1, s[24:27], s55 offen offset:3456
  s_call_b64 s[20:21], L_agent
  s_waitcnt vmcnt(0)
  v_perm_b32 v8, v204, v200, s50
  v_perm_b32 v9, v220, v216, s50
  v_perm_b32 v10, v212, v208, s50
  v_perm_b32 v11, v228, v224, s50
  v_perm_b32 v16, v204, v200, s51
  v_perm_b32 v17, v220, v216, s51
  v_perm_b32 v18, v212, v208, s51
  v_perm_b32 v19, v228, v224, s51
  v_perm_b32 v24, v205, v201, s50
  v_perm_b32 v25, v221, v217, s50
  v_perm_b32 v26, v213, v209, s50
  v_perm_b32 v27, v229, v225, s50
  v_perm_b32 v32, v205, v201, s51
  v_perm_b32 v33, v221, v217, s51
  v_perm_b32 v34, v213, v209, s51
  v_perm_b32 v35, v229, v225, s51
  v_perm_b32 v40, v206, v202, s50
  v_perm_b32 v41, v222, v218, s50
  v_perm_b32 v42, v214, v210, s50
  v_perm_b32 v43, v230, v226, s50
  v_perm_b32 v48, v206, v202, s51
  v_perm_b32 v49, v222, v218, s51
  v_perm_b32 v50, v214, v210, s51
  v_perm_b32 v51, v230, v226, s51
  s_mov_b32 s55, 36864
  buffer_load_dwordx3 v[200:202], v1, s[24:27], s55 offen offset:0
  buffer_load_dwordx3 v[204:206], v1, s[24:27], s55 offen offset:1152
  s_call_b64 s[20:21], L_agent
  s_waitcnt vmcnt(0)
  buffer_load_dwordx3 v[208:210], v1, s[24:27], s55 offen offset:2304
  buffer_load_dwordx3 v[212:214], v1, s[24:27], s55 offen offset:3456
  s_call_b64 s[20:21], L_agent
  s_waitcnt vmcnt(0)
  s_mov_b32 s55, 46080
  buffer_load_dwordx3 v[216:218], v1, s[24:27], s55 offen offset:0
  buffer_load_dwordx3 v[220:222], v1, s[24:27], s55 offen offset:1152
  s_call_b64 s[20:21], L_agent
  s_waitcnt vmcnt(0)
  buffer_load_dwordx3 v[224:226], v1, s[24:27], s55 offen offset:2304
  buffer_load_dwordx3 v[228:230], v1, s[24:27], s55 offen offset:3456
  s_call_b64 s[20:21], L_agent
  s_waitcnt vmcnt(0)
  v_perm_b32 v12, v204, v200, s50
  v_perm_b32 v13, v220, v216, s50
  v_perm_b32 v14, v212, v208, s50
  v_perm_b32 v15, v228, v224, s50
  v_perm_b32 v20, v204, v200, s51
  v_perm_b32 v21, v220, v216, s51
  v_perm_b32 v22, v212, v208, s51
  v_perm_b32 v23, v228, v224, s51
  v_perm_b32 v28, v205, v201, s50
  v_perm_b32 v29, v221, v217, s50
  v_perm_b32 v30, v213, v209, s50
  v_perm_b32 v31, v229, v225, s50
  v_perm_b32 v36, v205, v201, s51
  v_perm_b32 v37, v221, v217, s51
  v_perm_b32 v38, v213, v209, s51
  v_perm_b32 v39, v229, v225, s51
  v_perm_b32 v44, v206, v202, s50
  v_perm_b32 v45, v222, v218, s50
  v_perm_b32 v46, v214, v210, s50
  v_perm_b32 v47, v230, v226, s50
  v_perm_b32 v52, v206, v202, s51
  v_perm_b32 v53, v222, v218, s51
  v_perm_b32 v54, v214, v210, s51
  v_perm_b32 v55, v230, v226, s51
  s_mov_b32 s55, 73728
  buffer_load_dwordx3 v[200:202], v1, s[24:27], s55 offen offset:0
  buffer_load_dwordx3 v[204:206], v1, s[24:27], s55 offen offset:1152
  s_call_b64 s[20:21], L_agent
  s_waitcnt vmcnt(0)
  buffer_load_dwordx3 v[208:210], v1, s[24:27], s55 offen offset:2304
  buffer_load_dwordx3 v[212:214], v1, s[24:27], s55 offen offset:3456
  s_call_b64 s[20:21], L_agent
  s_waitcnt vmcnt(0)
  s_mov_b32 s55, 82944
  buffer_load_dwordx3 v[216:218], v1, s[24:27], s55 offen offset:0
  buffer_load_dwordx3 v[220:222], v1, s[24:27], s55 offen offset:1152
  s_call_b64 s[20:21], L_agent
  s_waitcnt vmcnt(0)
  buffer_load_dwordx3 v[224:226], v1, s[24:27], s55 offen offset:2304
  buffer_load_dwordx3 v[228:230], v1, s[24:27], s55 offen offset:3456
  s_call_b64 s[20:21], L_agent
  s_waitcnt vmcnt(0)
  v_perm_b32 v56, v204, v200, s50
  v_perm_b32 v57, v220, v216, s50
  v_perm_b32 v58, v212, v208, s50
  v_perm_b32 v59, v228, v224, s50
  v_perm_b32 v64, v204, v200, s51
  v_perm_b32 v65, v220, v216, s51
  v_perm_b32 v66, v212, v208, s51
  v_perm_b32 v67, v228, v224, s51
  v_perm_b32 v72, v205, v201, s50
  v_perm_b32 v73, v221, v217, s50
  v_perm_b32 v74, v213, v209, s50
  v_perm_b32 v75, v229, v225, s50
  v_perm_b32 v80, v205, v201, s51
  v_perm_b32 v81, v221, v217, s51
  v_perm_b32 v82, v213, v209, s51
  v_perm_b32 v83, v229, v225, s51
  v_perm_b32 v88, v206, v202, s50
  v_perm_b32 v89, v222, v218, s50
  v_perm_b32 v90, v214, v210, s50
  v_perm_b32 v91, v230, v226, s50
  v_perm_b32 v96, v206, v202, s51
  v_perm_b32 v97, v222, v218, s51
  v_perm_b32 v98, v214, v210, s51
  v_perm_b32 v99, v230, v226, s51
  s_mov_b32 s55, 110592
  buffer_load_dwordx3 v[200:202], v1, s[24:27], s55 offen offset:0
  buffer_load_dwordx3 v[204:206], v1, s[24:27], s55 offen offset:1152
  s_call_b64 s[20:21], L_agent
  s_waitcnt vmcnt(0)
  buffer_load_dwordx3 v[208:210], v1, s[24:27], s55 offen offset:2304
  buffer_load_dwordx3 v[212:214], v1, s[24:27], s55 offen offset:3456
  s_call_b64 s[20:21], L_agent
  s_waitcnt vmcnt(0)
  s_mov_b32 s55, 119808
  buffer_load_dwordx3 v[216:218], v1, s[24:27], s55 offen offset:0
  buffer_load_dwordx3 v[220:222], v1, s[24:27], s55 offen offset:1152
  s_call_b64 s[20:21], L_agent
  s_waitcnt vmcnt(0)
  buffer_load_dwordx3 v[224:226], v1, s[24:27], s55 offen offset:2304
  buffer_load_dwordx3 v[228:230], v1, s[24:27], s55 offen offset:3456
  s_call_b64 s[20:21], L_agent
  s_waitcnt vmcnt(0)
  v_perm_b32 v60, v204, v200, s50
  v_perm_b32 v61, v220, v216, s50
  v_perm_b32 v62, v212, v208, s50
  v_perm_b32 v63, v228, v224, s50
  v_perm_b32 v68, v204, v200, s51
  v_perm_b32 v69, v220, v216, s51
  v_perm_b32 v70, v212, v208, s51
  v_perm_b32 v71, v228, v224, s51
  v_perm_b32 v76, v205, v201, s50
  v_perm_b32 v77, v221, v217, s50
  v_perm_b32 v78, v213, v209, s50
  v_perm_b32 v79, v229, v225, s50
  v_perm_b32 v84, v205, v201, s51
  v_perm_b32 v85, v221, v217, s51
  v_perm_b32 v86, v213, v209, s51
  v_perm_b32 v87, v229, v225, s51
  v_perm_b32 v92, v206, v202, s50
  v_perm_b32 v93, v222, v218, s50
  v_perm_b32 v94, v214, v210, s50
  v_perm_b32 v95, v230, v226, s50
  v_perm_b32 v100, v206, v202, s51
  v_perm_b32 v101, v222, v218, s51
  v_perm_b32 v102, v214, v210, s51
  v_perm_b32 v103, v230, v226, s51
  s_mov_b32 s55, 147456
  buffer_load_dwordx3 v[200:202], v1, s[24:27], s55 offen offset:0
  buffer_load_dwordx3 v[204:206], v1, s[24:27], s55 offen offset:1152
  s_call_b64 s[20:21], L_agent
  s_waitcnt vmcnt(0)
  buffer_load_dwordx3 v[208:210], v1, s[24:27], s55 offen offset:2304
  buffer_load_dwordx3 v[212:214], v1, s[24:27], s55 offen offset:3456
  s_call_b64 s[20:21], L_agent
  s_waitcnt vmcnt(0)
  s_mov_b32 s55, 156672
  buffer_load_dwordx3 v[216:218], v1, s[24:27], s55 offen offset:0
  buffer_load_dwordx3 v[220:222], v1, s[24:27], s55 offen offset:1152
  s_call_b64 s[20:21], L_agent
  s_waitcnt vmcnt(0)
  buffer_load_dwordx3 v[224:226], v1, s[24:27], s55 offen offset:2304
  buffer_load_dwordx3 v[228:230], v1, s[24:27], s55 offen offset:3456
  s_call_b64 s[20:21], L_agent
  s_waitcnt vmcnt(0)
  v_perm_b32 v104, v204, v200, s50
  v_perm_b32 v105, v220, v216, s50
  v_perm_b32 v106, v212, v208, s50
  v_perm_b32 v107, v228, v224, s50
  v_perm_b32 v112, v204, v200, s51
  v_perm_b32 v113, v220, v216, s51
  v_perm_b32 v114, v212, v208, s51
  v_perm_b32 v115, v228, v224, s51
  v_perm_b32 v120, v205, v201, s50
  v_perm_b32 v121, v221, v217, s50
  v_perm_b32 v122, v213, v209, s50
  v_perm_b32 v123, v229, v225, s50
  v_perm_b32 v128, v205, v201, s51
  v_perm_b32 v129, v221, v217, s51
  v_perm_b32 v130, v213, v209, s51
  v_perm_b32 v131, v229, v225, s51
  v_perm_b32 v136, v206, v202, s50
  v_perm_b32 v137, v222, v218, s50
  v_perm_b32 v138, v214, v210, s50
  v_perm_b32 v139, v230, v226, s50
  v_perm_b32 v144, v206, v202, s51
  v_perm_b32 v145, v222, v218, s51
  v_perm_b32 v146, v214, v210, s51
  v_perm_b32 v147, v230, v226, s51
  s_mov_b32 s55, 184320
  buffer_load_dwordx3 v[200:202], v1, s[24:27], s55 offen offset:0
  buffer_load_dwordx3 v[204:206], v1, s[24:27], s55 offen offset:1152
  s_call_b64 s[20:21], L_agent
  s_waitcnt vmcnt(0)
  buffer_load_dwordx3 v[208:210], v1, s[24:27], s55 offen offset:2304
  buffer_load_dwordx3 v[212:214], v1, s[24:27], s55 offen offset:3456
  s_call_b64 s[20:21], L_agent
  s_waitcnt vmcnt(0)
  s_mov_b32 s55, 193536
  buffer_load_dwordx3 v[216:218], v1, s[24:27], s55 offen offset:0
  buffer_load_dwordx3 v[220:222], v1, s[24:27], s55 offen offset:1152
  s_call_b64 s[20:21], L_agent
  s_waitcnt vmcnt(0)
  buffer_load_dwordx3 v[224:226], v1, s[24:27], s55 offen offset:2304
  buffer_load_dwordx3 v[228:230], v1, s[24:27], s55 offen offset:3456
  s_call_b64 s[20:21], L_agent
  s_waitcnt vmcnt(0)
  v_perm_b32 v108, v204, v200, s50
  v_perm_b32 v109, v220, v216, s50
  v_perm_b32 v110, v212, v208, s50
  v_perm_b32 v111, v228, v224, s50
  v_perm_b32 v116, v204, v200, s51
  v_perm_b32 v117, v220, v216, s51
  v_perm_b32 v118, v212, v208, s51
  v_perm_b32 v119, v228, v224, s51
  v_perm_b32 v124, v205, v201, s50
  v_perm_b32 v125, v221, v217, s50
  v_perm_b32 v126, v213, v209, s50
  v_perm_b32 v127, v229, v225, s50
  v_perm_b32 v132, v205, v201, s51
  v_perm_b32 v133, v221, v217, s51
  v_perm_b32 v134, v213, v209, s51
  v_perm_b32 v135, v229, v225, s51
  v_perm_b32 v140, v206, v202, s50
  v_perm_b32 v141, v222, v218, s50
  v_perm_b32 v142, v214, v210, s50
  v_perm_b32 v143, v230, v226, s50
  v_perm_b32 v148, v206, v202, s51
  v_perm_b32 v149, v222, v218, s51
  v_perm_b32 v150, v214, v210, s51
  v_perm_b32 v151, v230, v226, s51
  s_mov_b32 s55, 221184
  buffer_load_dwordx3 v[200:202], v1, s[24:27], s55 offen offset:0
  buffer_load_dwordx3 v[204:206], v1, s[24:27], s55 offen offset:1152
  s_call_b64 s[20:21], L_agent
  s_waitcnt vmcnt(0)
  buffer_load_dwordx3 v[208:210], v1, s[24:27], s55 offen offset:2304
  buffer_load_dwordx3 v[212:214], v1, s[24:27], s55 offen offset:3456
  s_call_b64 s[20:21], L_agent
  s_waitcnt vmcnt(0)
  s_mov_b32 s55, 230400
  buffer_load_dwordx3 v[216:218], v1, s[24:27], s55 offen offset:0
  buffer_load_dwordx3 v[220:222], v1, s[24:27], s55 offen offset:1152
  s_call_b64 s[20:21], L_agent
  s_waitcnt vmcnt(0)
  buffer_load_dwordx3 v[224:226], v1, s[24:27], s55 offen offset:2304
  buffer_load_dwordx3 v[228:230], v1, s[24:27], s55 offen offset:3456
  s_call_b64 s[20:21], L_agent
  s_waitcnt vmcnt(0)
  v_perm_b32 v152, v204, v200, s50
  v_perm_b32 v153, v220, v216, s50
  v_perm_b32 v154, v212, v208, s50
  v_perm_b32 v155, v228, v224, s50
  v_perm_b32 v160, v204, v200, s51
  v_perm_b32 v161, v220, v216, s51
  v_perm_b32 v162, v212, v208, s51
  v_perm_b32 v163, v228, v224, s51
  v_perm_b32 v168, v205, v201, s50
  v_perm_b32 v169, v221, v217, s50
  v_perm_b32 v170, v213, v209, s50
  v_perm_b32 v171, v229, v225, s50
  v_perm_b32 v176, v205, v201, s51
  v_perm_b32 v177, v221, v217, s51
  v_perm_b32 v178, v213, v209, s51
  v_perm_b32 v179, v229, v225, s51
  v_perm_b32 v184, v206, v202, s50
  v_perm_b32 v185, v222, v218, s50
  v_perm_b32 v186, v214, v210, s50
  v_perm_b32 v187, v230, v226, s50
  v_perm_b32 v192, v206, v202, s51
  v_perm_b32 v193, v222, v218, s51
  v_perm_b32 v194, v214, v210, s51
  v_perm_b32 v195, v230, v226, s51
  s_mov_b32 s55, 258048
  buffer_load_dwordx3 v[200:202], v1, s[24:27], s55 offen offset:0
  buffer_load_dwordx3 v[204:206], v1, s[24:27], s55 offen offset:1152
  s_call_b64 s[20:21], L_agent
  s_waitcnt vmcnt(0)
  buffer_load_dwordx3 v[208:210], v1, s[24:27], s55 offen offset:2304
  buffer_load_dwordx3 v[212:214], v1, s[24:27], s55 offen offset:3456
  s_call_b64 s[20:21], L_agent
  s_waitcnt vmcnt(0)
  s_mov_b32 s55, 267264
  buffer_load_dwordx3 v[216:218], v1, s[24:27], s55 offen offset:0
  buffer_load_dwordx3 v[220:222], v1, s[24:27], s55 offen offset:1152
  s_call_b64 s[20:21], L_agent
  s_waitcnt vmcnt(0)
  buffer_load_dwordx3 v[224:226], v1, s[24:27], s55 offen offset:2304
  buffer_load_dwordx3 v[228:230], v1, s[24:27], s55 offen offset:3456
  s_call_b64 s[20:21], L_agent
  s_waitcnt vmcnt(0)
  v_perm_b32 v156, v204, v200, s50
  v_perm_b32 v157, v220, v216, s50
  v_perm_b32 v158, v212, v208, s50
  v_perm_b32 v159, v228, v224, s50
  v_perm_b32 v164, v204, v200, s51
  v_perm_b32 v165, v220, v216, s51
  v_perm_b32 v166, v212, v208, s51
  v_perm_b32 v167, v228, v224, s51
  v_perm_b32 v172, v205, v201, s50
  v_perm_b32 v173, v221, v217, s50
  v_perm_b32 v174, v213, v209, s50
  v_perm_b32 v175, v229, v225, s50
  v_perm_b32 v180, v205, v201, s51
  v_perm_b32 v181, v221, v217, s51
  v_perm_b32 v182, v213, v209, s51
  v_perm_b32 v183, v229, v225, s51
  v_perm_b32 v188, v206, v202, s50
  v_perm_b32 v189, v222, v218, s50
  v_perm_b32 v190, v214, v210, s50
  v_perm_b32 v191, v230, v226, s50
  v_perm_b32 v196, v206, v202, s51
  v_perm_b32 v197, v222, v218, s51
  v_perm_b32 v198, v214, v210, s51
  v_perm_b32 v199, v230, v226, s51
  s_lshl_b32 s55, s49, 3
  s_lshr_b32 s56, s48, 1
  s_add_u32 s55, s55, s56
  s_mul_i32 s55, s55, 1152
  s_mul_i32 s56, s58, 192
  s_add_u32 s55, s55, s56
  s_and_b32 s56, s48, 1
  s_mul_i32 s56, s56, 96
  s_add_u32 s55, s55, s56
  v_mul_u32_u24 v232, 12, v235
  v_lshl_add_u32 v232, v236, 2, v232
  v_add_u32 v1, s55, v232
  s_cmp_lg_u32 s3, 3
  s_cbranch_scc1 L_nochk
  s_mov_b32 s56, 0x40000
L_chk:
  buffer_load_dword v232, v237, s[12:15], 0 offen sc1
  s_waitcnt vmcnt(0)
  v_readfirstlane_b32 s55, v232
  s_sub_u32 s56, s56, 1
  s_cbranch_scc1 L_chkd
  s_cmp_lg_u32 s55, 0
  s_cbranch_scc1 L_chkd
  s_sleep 8
  s_branch L_chk
L_chkd:
  ds_write_b32 v238, v232 offset:520
  v_mov_b32 v233, 1
  s_mov_b64 exec, 1
  s_waitcnt lgkmcnt(0)
  ds_add_u32 v238, v233 offset:524
  s_mov_b64 exec, -1
L_nochk:
  v_mov_b32 v3, 131072
  v_and_b32 v233, 1, v0
  v_mul_u32_u24 v4, 0xaaaa, v233
  v_add_u32 v4, 0x4444, v4
  v_lshlrev_b32 v233, 4, v233
  v_mov_b32 v234, 0x3f80
  v_lshlrev_b32 v233, v233, v234
  v_and_b32 v234, 14, v0
  v_cmp_eq_u32 vcc, 0, v234
  s_nop 1
  v_cndmask_b32 v224, 0, v233, vcc
  v_cmp_eq_u32 vcc, 4, v234
  s_nop 1
  v_cndmask_b32 v225, 0, v233, vcc
  v_cmp_eq_u32 vcc, 8, v234
  s_nop 1
  v_cndmask_b32 v226, 0, v233, vcc
  v_mov_b32 v227, 0
  s_mov_b32 s54, 0
  s_mov_b32 s30, 0
  s_mov_b32 s10, 0
  s_mov_b32 s62, 0
L_w0:
  s_call_b64 s[20:21], L_agent
  s_waitcnt vmcnt(0)
  ds_read_b32 v200, v3 offset:524
  s_waitcnt lgkmcnt(0)
  v_readfirstlane_b32 s55, v200
  s_cmp_ge_u32 s55, 3
  s_cbranch_scc1 L_w0_d
  s_sleep 8
  s_branch L_w0
L_w0_d:
  s_call_b64 s[20:21], L_agent
  s_waitcnt vmcnt(0)
  s_mov_b32 s23, 0
  ds_read_b32 v2, v3 offset:520
  v_mov_b32 v232, 0
  v_mov_b32 v233, 0
  v_mov_b32 v234, 0
  v_mov_b32 v235, 0
  v_mov_b32 v236, 0
  v_mov_b32 v237, 0
  v_mov_b32 v238, 0
  v_mov_b32 v239, 0
  v_mov_b32 v240, 0
  v_mov_b32 v241, 0
  v_mov_b32 v242, 0
  v_mov_b32 v243, 0
  v_mov_b32 v244, 0
  v_mov_b32 v245, 0
  v_mov_b32 v246, 0
  v_mov_b32 v247, 0
  v_mov_b32 v248, 0
  v_mov_b32 v249, 0
  v_mov_b32 v250, 0
  v_mov_b32 v251, 0
  v_mov_b32 v252, 0
  v_mov_b32 v253, 0
  v_mov_b32 v254, 0
  v_mov_b32 v255, 0
  s_waitcnt lgkmcnt(0)
  v_mov_b32 v219, v2
  s_branch L_tail
L_barB:
  s_mov_b64 exec, -1
  s_waitcnt vmcnt(0)
L_agl:
  s_cmp_gt_u32 s22, 192
  s_cbranch_scc1 L_agd
  s_call_b64 s[20:21], L_agent
  s_waitcnt vmcnt(0)
  s_sleep 4
  s_branch L_agl
L_agd:
  s_call_b64 s[20:21], L_agent
  v_mov_b32 v232, 0
  v_mov_b32 v233, 0
  v_mov_b32 v234, 0
  v_mov_b32 v235, 0
  v_mov_b32 v236, 0
  v_mov_b32 v237, 0
  v_mov_b32 v238, 0
  v_mov_b32 v239, 0
  v_mov_b32 v240, 0
  v_mov_b32 v241, 0
  v_mov_b32 v242, 0
  v_mov_b32 v243, 0
  v_mov_b32 v244, 0
  v_mov_b32 v245, 0
  v_mov_b32 v246, 0
  v_mov_b32 v247, 0
  v_mov_b32 v248, 0
  v_mov_b32 v249, 0
  v_mov_b32 v250, 0
  v_mov_b32 v251, 0
  v_mov_b32 v252, 0
  v_mov_b32 v253, 0
  v_mov_b32 v254, 0
  v_mov_b32 v255, 0
  v_mov_b32 v220, v216
  v_mov_b32 v221, v217
  v_mov_b32 v222, v218
  v_mov_b32 v223, v219
  v_add_u32 v5, 4352, v5
  s_mov_b32 s54, 98304
  s_mov_b32 s30, 200704
  s_mov_b32 s10, 147456
  s_mov_b32 s62, 0x40000
  s_setprio 2
  s_barrier
L_tail:
  ds_read_b128 v[200:203], v5 offset:0
  ds_read_b128 v[204:207], v5 offset:128
  ds_read_b128 v[208:211], v5 offset:256
  ds_read_b128 v[212:215], v5 offset:384
  buffer_store_dwordx4 v[220:223], v6, s[28:31], 0 offen sc1
  s_waitcnt lgkmcnt(3)
  v_smfmac_f32_16x16x64_bf16 v[232:235], v[200:203], v[8:15], v4
  s_waitcnt lgkmcnt(2)
  v_smfmac_f32_16x16x64_bf16 v[232:235], v[204:207], v[56:63], v4
  s_waitcnt lgkmcnt(1)
  v_smfmac_f32_16x16x64_bf16 v[232:235], v[208:211], v[104:111], v4
  s_waitcnt lgkmcnt(0)
  v_smfmac_f32_16x16x64_bf16 v[232:235], v[212:215], v[152:159], v4
  v_smfmac_f32_16x16x64_bf16 v[236:239], v[200:203], v[16:23], v4
  v_smfmac_f32_16x16x64_bf16 v[236:239], v[204:207], v[64:71], v4
  v_smfmac_f32_16x16x64_bf16 v[236:239], v[208:211], v[112:119], v4
  v_smfmac_f32_16x16x64_bf16 v[236:239], v[212:215], v[160:167], v4
  v_smfmac_f32_16x16x64_bf16 v[240:243], v[200:203], v[24:31], v4
  v_smfmac_f32_16x16x64_bf16 v[240:243], v[204:207], v[72:79], v4
  v_smfmac_f32_16x16x64_bf16 v[240:243], v[208:211], v[120:127], v4
  v_smfmac_f32_16x16x64_bf16 v[240:243], v[212:215], v[168:175], v4
  v_pk_add_f32 v[232:233], v[232:233], v[234:235]
  v_add_f32 v232, v232, v233
  v_smfmac_f32_16x16x64_bf16 v[244:247], v[200:203], v[32:39], v4
  v_smfmac_f32_16x16x64_bf16 v[244:247], v[204:207], v[80:87], v4
  v_smfmac_f32_16x16x64_bf16 v[244:247], v[208:211], v[128:135], v4
  v_smfmac_f32_16x16x64_bf16 v[244:247], v[212:215], v[176:183], v4
  v_pk_add_f32 v[236:237], v[236:237], v[238:239]
  v_add_f32 v236, v236, v237
  v_cvt_pk_bf16_f32 v216, v232, v236
  v_smfmac_f32_16x16x64_bf16 v[248:251], v[200:203], v[40:47], v4
  v_smfmac_f32_16x16x64_bf16 v[248:251], v[204:207], v[88:95], v4
  v_smfmac_f32_16x16x64_bf16 v[248:251], v[208:211], v[136:143], v4
  v_smfmac_f32_16x16x64_bf16 v[248:251], v[212:215], v[184:191], v4
  v_pk_add_f32 v[240:241], v[240:241], v[242:243]
  v_add_f32 v240, v240, v241
  v_smfmac_f32_16x16x64_bf16 v[252:255], v[200:203], v[48:55], v4
  v_smfmac_f32_16x16x64_bf16 v[252:255], v[204:207], v[96:103], v4
  v_smfmac_f32_16x16x64_bf16 v[252:255], v[208:211], v[144:151], v4
  v_smfmac_f32_16x16x64_bf16 v[252:255], v[212:215], v[192:199], v4
  v_pk_add_f32 v[244:245], v[244:245], v[246:247]
  v_add_f32 v244, v244, v245
  v_cvt_pk_bf16_f32 v217, v240, v244
  s_nop 0
  v_pk_add_f32 v[248:249], v[248:249], v[250:251]
  v_add_f32 v248, v248, v249
  s_nop 1
  v_pk_add_f32 v[252:253], v[252:253], v[254:255]
  v_add_f32 v252, v252, v253
  v_cvt_pk_bf16_f32 v218, v248, v252
  buffer_store_dwordx4 v[216:219], v6, s[28:31], s54 offen sc1
  s_setprio 0
  s_mov_b32 s56, s62
L_pbo:
  s_sleep 20
L_poll:
  buffer_load_dwordx4 v[200:203], v7, s[28:31], 0 offen offset:0 sc1
  buffer_load_dwordx4 v[204:207], v7, s[28:31], 0 offen offset:2048 sc1
  s_waitcnt vmcnt(0)
  v_cmp_ne_u32 vcc, v203, v2
  v_cmp_ne_u32 s[60:61], v207, v2
  s_or_b64 exec, vcc, s[60:61]
  s_cbranch_scc0 L_pdone
  s_sub_u32 s56, s56, 1
  s_cbranch_scc1 L_pdone
  s_cmp_eq_u64 exec, -1
  s_cbranch_scc0 L_poll
  s_branch L_pbo
L_pdone:
  s_mov_b64 exec, -1
  v_mov_b32 v203, 0
  v_mov_b32 v207, 0
  s_nop 0
  v_mfma_f32_16x16x32_bf16 v[228:231], v[224:227], v[200:203], 0
  v_mfma_f32_16x16x32_bf16 v[228:231], v[224:227], v[204:207], v[228:231]
  s_mov_b32 vcc_lo, 0x00ff00ff
  s_mov_b32 vcc_hi, 0x000000ff
  s_nop 5
  v_add_f32_dpp v228, v228, v228 row_ror:8 row_mask:0xf bank_mask:0xf
  v_add_f32_dpp v229, v229, v229 row_ror:8 row_mask:0xf bank_mask:0xf
  s_mov_b64 exec, vcc
  v_cvt_pk_bf16_f32 v230, v228, v229
  buffer_store_dword v230, v1, s[8:11], 0 offen
  s_cmp_eq_u32 s54, 0
  s_cbranch_scc1 L_barB
L_end:
  s_endpgm
L_agent:
  s_cmp_eq_u32 s23, 0
  s_cbranch_scc1 L_ag1
  s_mov_b32 s23, 0
  v_sub_u32 v244, v244, v252
  v_add_u32 v248, 0x1000, v244
  v_sub_u32 v245, v245, v252
  v_add_u32 v249, 0x1000, v245
  v_sub_u32 v246, v246, v252
  v_add_u32 v250, 0x1000, v246
  v_sub_u32 v247, v247, v252
  v_add_u32 v251, 0x1000, v247
  v_max_u32 v248, v248, v249
  v_max3_u32 v248, v248, v250, v251
  v_cmp_gt_u32 vcc, 0x1200, v248
  v_add_u32 v244, v244, v245
  v_add_u32 v245, v246, v247
  v_cvt_f32_i32 v244, v244
  v_cvt_f32_i32 v245, v245
  v_cndmask_b32 v244, 0, v244, vcc
  v_cndmask_b32 v245, 0, v245, vcc
  s_bcnt1_i32_b64 s5, vcc
  s_nop 0
  v_add_f32_dpp v244, v244, v244 row_ror:8 row_mask:0xf bank_mask:0xf
  v_add_f32_dpp v245, v245, v245 row_ror:8 row_mask:0xf bank_mask:0xf
  s_nop 0
  v_add_f32_dpp v244, v244, v244 row_ror:4 row_mask:0xf bank_mask:0xf
  v_add_f32_dpp v245, v245, v245 row_ror:4 row_mask:0xf bank_mask:0xf
  s_nop 0
  v_add_f32_dpp v244, v244, v244 row_ror:2 row_mask:0xf bank_mask:0xf
  v_add_f32_dpp v245, v245, v245 row_ror:2 row_mask:0xf bank_mask:0xf
  s_nop 0
  v_add_f32_dpp v244, v244, v244 row_ror:1 row_mask:0xf bank_mask:0xf
  v_add_f32_dpp v245, v245, v245 row_ror:1 row_mask:0xf bank_mask:0xf
  v_mov_b32 v246, v244
  v_mov_b32 v247, v245
  s_nop 1
  v_permlane32_swap_b32 v244, v246
  v_permlane32_swap_b32 v245, v247
  s_nop 1
  v_add_f32 v244, v244, v246
  v_add_f32 v245, v245, v247
  v_mov_b32 v246, v244
  v_mov_b32 v247, v245
  s_nop 1
  v_permlane16_swap_b32 v244, v246
  v_permlane16_swap_b32 v245, v247
  s_nop 1
  v_add_f32 v244, v244, v246
  v_add_f32 v245, v245, v247
  v_cvt_f32_u32 v246, s5
  v_rcp_f32 v246, v246
  v_sub_f32 v244, v245, v244
  v_mul_f32 v244, 0x3dff7cee, v244
  v_mul_f32 v245, 0.5, v245
  v_mul_f32 v244, v244, v246
  v_mul_f32 v245, v245, v246
  s_sub_i32 s6, 160, s22
  v_cvt_f32_i32 v247, s6
  v_mul_f32 v247, 0x3e000000, v247
  v_fmac_f32 v245, v247, v244
  v_mul_f32 v244, 0x41800000, v244
  v_cvt_i32_f32 v247, v244
  v_cvt_i32_f32 v246, v245
  v_add_u32 v246, 76, v246
  v_add_u32 v246, v246, v252
  v_mov_b32 v254, 131072
  s_cmp_lt_u32 s5, 32
  s_cbranch_scc1 L_ag1
  ds_write_b64 v254, v[246:247] offset:26136
L_ag1:
  s_cmp_gt_u32 s22, 192
  s_cbranch_scc1 L_agr
  s_add_u32 s5, s22, 131072
  v_mov_b32 v254, s5
  ds_read_b64 v[248:249], v254 offset:25856
  ds_read_b64 v[250:251], v254 offset:25888
  s_waitcnt lgkmcnt(0)
  v_min_u32 v253, v250, v251
  v_mov_b32 v252, v250
  v_readfirstlane_b32 s5, v253
  s_cmp_eq_u32 s5, 0
  s_cbranch_scc1 L_agr
  s_mul_i32 s5, s22, 144
  v_lshlrev_b32 v254, 4, v0
  buffer_load_dwordx4 v[244:247], v254, s[16:19], s5 offen
  s_add_u32 s22, s22, 16
  s_mov_b32 s23, 1
  s_and_b32 s6, s2, 24
  s_cbranch_scc1 L_agr
  s_add_u32 s5, s5, s4
  s_mov_b64 exec, 1
  buffer_store_dwordx4 v[248:251], v254, s[16:19], s5 offen sc1
  s_mov_b64 exec, -1
L_agr:
  s_setpc_b64 s[20:21]
.section .rodata,"a"
.p2align 6
.amdhsa_kernel standalone__gqa_block_cached__sampling_kernel
  .amdhsa_next_free_vgpr 256
  .amdhsa_next_free_sgpr 96
  .amdhsa_accum_offset 256
  .amdhsa_group_segment_fixed_size 0
  .amdhsa_kernarg_size 64
  .amdhsa_user_sgpr_count 2
  .amdhsa_user_sgpr_kernarg_segment_ptr 1
  .amdhsa_system_sgpr_workgroup_id_x 1
.end_amdhsa_kernel
```
